```python
import torch

def _softmax(x, axis=-1):
    return torch.softmax(x, dim=axis)

def _gelu(x):
    return torch.nn.functional.gelu(x, approximate='tanh')

def _silu(x):
    return torch.nn.functional.silu(x)

def _sigmoid(x):
    return torch.sigmoid(x)

def _layernorm(x, axis=-1, eps=1e-05):
    m = x.mean(dim=axis, keepdim=True)
    v = x.var(dim=axis, keepdim=True, unbiased=False)
    return (x - m) / torch.sqrt(v + eps)

def _scatter_add(tgt, idx, src, axis=0):
    return tgt.clone().index_add_(axis, idx, src)

def _segment_sum(src, seg, n):
    out = torch.zeros((n,) + src.shape[1:], dtype=src.dtype)
    return out.index_add_(0, seg, src)

def _pad(x, pw):
    flat = tuple((v for pair in reversed(pw) for v in pair))
    return torch.nn.functional.pad(x, flat)
kernel_name = 'adaLN_cond__gqa_block_cached__geglu_ffn__decode'

def setup_inputs():

    _w = lambda a: (lambda t: t.to(torch.bfloat16) if t.is_floating_point() else t)(torch.as_tensor(a))

    def _A_setup():
        B, Sq, D = (1, 1, 576)
        Hq, Hkv, Sk, Dh = (32, 16, 32768, 128)
        assert Hq % Hkv == 0, (Hq, Hkv)
        return {'x': _w((lambda *s: torch.randn(*s, dtype=torch.bfloat16) * 0.1)(B, Sq, D)), 'k_cache': _w((lambda *s: torch.randn(*s, dtype=torch.bfloat16) * 0.8)(B, Hkv, Sk, Dh)), 'v_cache': _w((lambda *s: torch.randn(*s, dtype=torch.bfloat16) * 1.6)(B, Hkv, Sk, Dh)), 'wq': _w((lambda *s: torch.randn(*s, dtype=torch.bfloat16) * 0.8)(D, Hq * Dh) * D ** (-0.5)), 'wo': _w((lambda *s: torch.randn(*s, dtype=torch.bfloat16) * 1.6)(Hq * Dh, D) * (Hq * Dh) ** (-0.5))}
    _A_in = _A_setup()

    def _B_setup():
        B, S, D, F = (1, 1, 576, 4608)
        return {'x': _w((lambda *s: torch.randn(*s, dtype=torch.bfloat16) * 0.1)(B, S, D)), 'w_gate': _w((lambda *s: torch.randn(*s, dtype=torch.bfloat16) * 0.4)(D, F)), 'w_up': _w((lambda *s: torch.randn(*s, dtype=torch.bfloat16) * 0.4)(D, F)), 'w_down': _w((lambda *s: torch.randn(*s, dtype=torch.bfloat16) * 0.4)(F, D))}
    _B_in = _B_setup()
    return {'A_x': _A_in['x'], 'A_k_cache': _A_in['k_cache'], 'A_v_cache': _A_in['v_cache'], 'A_wq': _A_in['wq'], 'A_wo': _A_in['wo'], 'B_x': _B_in['x'], 'B_w_gate': _B_in['w_gate'], 'B_w_up': _B_in['w_up'], 'B_w_down': _B_in['w_down'], 'c': _w((lambda *s: torch.randn(*s, dtype=torch.bfloat16) * 0.4)(1, 576) * 8.0), 'w_mod': _w((lambda *s: torch.randn(*s, dtype=torch.bfloat16) * 0.4)(576, 6 * 576) * 576 ** (-0.5) * 8.0)}

def reference(A_x, A_k_cache, A_v_cache, A_wq, A_wo, B_x, B_w_gate, B_w_up, B_w_down, c, w_mod):

    def _A_ref(x, k_cache, v_cache, wq, wo):
        B, Sq, D = x.shape
        Hq, Dh = (32, 128)
        Hkv = k_cache.shape[1]
        rep = Hq // Hkv
        q = (lambda x, *d: x.permute(*d))((x @ wq).reshape(B, Sq, Hq, Dh), 0, 2, 1, 3)
        k = (lambda x, n, axis: torch.repeat_interleave(x, n, dim=axis))(k_cache, rep, axis=1)
        v = (lambda x, n, axis: torch.repeat_interleave(x, n, dim=axis))(v_cache, rep, axis=1)
        scores = torch.einsum('bhqd,bhkd->bhqk', q, k) * Dh ** (-0.5)
        p = _softmax(scores, axis=-1)
        o = torch.einsum('bhqk,bhkd->bhqd', p, v)
        return (lambda x, *d: x.permute(*d))(o, 0, 2, 1, 3).reshape(B, Sq, Hq * Dh) @ wo

    def _B_ref(x, w_gate, w_up, w_down):
        return _gelu(x @ w_gate) * (x @ w_up) @ w_down
    x = A_x
    mod = (_silu(c) @ w_mod).reshape(c.shape[0], 6, 1, -1)
    sa, ca, ga, sb, cb, gb = (mod[:, 0].clone(), mod[:, 1].clone(), mod[:, 2].clone(), mod[:, 3].clone(), mod[:, 4].clone(), mod[:, 5].clone())
    h = _layernorm(x, axis=-1) * (1 + ca) + sa
    x = x + ga * _A_ref(h, A_k_cache, A_v_cache, A_wq, A_wo)
    h = _layernorm(x, axis=-1) * (1 + cb) + sb
    x = x + gb * _B_ref(h, B_w_gate, B_w_up, B_w_down)
    return x
```

```asm
; @launch grid=(256,1,1) block=(512,1,1) lds=53248
.amdgcn_target "amdgcn-amd-amdhsa--gfx950"
.text
.globl adaLN_cond__gqa_block_cached__geglu_ffn__decode_kernel
.p2align 8
.type adaLN_cond__gqa_block_cached__geglu_ffn__decode_kernel,@function
adaLN_cond__gqa_block_cached__geglu_ffn__decode_kernel:
    s_cmp_ge_u32 s2, 256
    s_cbranch_scc1 L_end
    s_load_dwordx16 s[4:19], s[0:1], 0
    s_load_dwordx8 s[20:27], s[0:1], 64
    s_load_dwordx2 s[28:29], s[0:1], 104
    v_lshrrev_b32 v1, 6, v0
    v_and_b32 v0, 63, v0
    v_readfirstlane_b32 s81, v1
    s_lshr_b32 s92, s2, 4
    s_add_u32 s92, s92, s2
    s_and_b32 s92, s92, 15
    s_and_b32 s2, s2, 0xf0
    s_or_b32 s2, s2, s92
    s_lshr_b32 s87, s2, 4
    s_and_b32 s88, s2, 15
    s_and_b32 s3, s87, 1
    s_sub_u32 s92, 5, s3
    s_sub_i32 s93, s88, 7
    s_max_i32 s93, s93, 0
    s_mov_b32 s86, 0x3fb8aa3b
    s_mul_i32 s94, s87, 14
    s_add_u32 s94, s94, s88
    s_sub_u32 s94, s94, 2
    s_cmp_lt_u32 s88, 2
    s_cselect_b32 s94, -1, s94
    s_cmp_lt_u32 s94, 216
    s_cselect_b32 s91, s94, -1
    s_mov_b32 s89, 2
    s_mov_b32 s90, s93
    s_cmp_lt_u32 s88, 7
    s_cbranch_scc0 L_cls_done
    s_lshr_b32 s95, s87, 1
    s_cmp_lt_u32 s88, s92
    s_cbranch_scc0 L_cls_mid
    s_mov_b32 s89, 0
    s_xor_b32 s90, s87, 1
    s_lshl_b32 s90, s90, 2
    s_add_u32 s90, s90, s88
    s_add_u32 s95, s95, 64
    s_cmp_eq_u32 s88, 4
    s_cselect_b32 s90, s95, s90
    s_branch L_cls_done
L_cls_mid:
    s_mov_b32 s89, 1
    s_mul_i32 s96, s95, 3
    s_add_u32 s96, s96, s88
    s_sub_u32 s96, s96, 4
    s_lshl_b32 s97, s95, 1
    s_add_u32 s97, s97, s88
    s_add_u32 s97, s97, 19
    s_cmp_eq_u32 s3, 1
    s_cselect_b32 s90, s96, s97
L_cls_done:
    s_cmp_eq_u32 s81, 7
    s_cbranch_scc1 L_service
    v_and_b32 v3, 15, v0
    v_lshlrev_b32 v1, 8, v3
    v_lshlrev_b32 v2, 4, v3
    v_lshrrev_b32 v3, 4, v0
    v_lshl_add_u32 v1, v3, 4, v1
    v_lshl_add_u32 v2, v3, 10, v2
    s_lshl_b32 s30, s87, 23
    s_lshl_b32 s55, s88, 19
    s_lshl_b32 s82, s81, 12
    s_add_u32 s82, s82, s55
    v_mov_b32 v14, 0
    v_mov_b32 v15, 1
    s_mov_b32 s84, 0x3db504f3
    s_mov_b32 s85, 0x3db504f3
    v_and_b32 v3, 1, v0
    v_mov_b32 v36, 0xffff
    v_mov_b32 v37, 0xffff0000
    v_cmp_eq_u32 vcc, 1, v3
    s_nop 1
    v_cndmask_b32 v36, v36, v37, vcc
    v_bfe_u32 v3, v0, 1, 2
    v_cmp_eq_u32 vcc, 0, v3
    s_nop 1
    v_cndmask_b32 v4, 0, v36, vcc
    v_cmp_eq_u32 vcc, 1, v3
    s_nop 1
    v_cndmask_b32 v5, 0, v36, vcc
    v_cmp_eq_u32 vcc, 2, v3
    s_nop 1
    v_cndmask_b32 v6, 0, v36, vcc
    v_cmp_eq_u32 vcc, 3, v3
    s_nop 1
    v_cndmask_b32 v7, 0, v36, vcc
    v_mov_b32 v8, 0
    v_mov_b32 v9, 0
    v_mov_b32 v10, 0xff7fffff
    v_mov_b32 v20, 0
    v_mov_b32 v21, 0
    v_mov_b32 v22, 0
    v_mov_b32 v23, 0
    v_bfe_u32 v3, v0, 3, 1
    v_lshlrev_b32 v3, 8, v3
    v_lshrrev_b32 v36, 4, v0
    v_lshl_add_u32 v3, v36, 4, v3
    s_waitcnt lgkmcnt(0)
    s_add_u32 s32, s6, s30
    s_addc_u32 s33, s7, 0
    s_and_b32 s33, s33, 0xffff
    s_mov_b32 s34, 8388608
    s_mov_b32 s35, 0x20000
    s_add_u32 s36, s8, s30
    s_addc_u32 s37, s9, 0
    s_and_b32 s37, s37, 0xffff
    s_mov_b32 s38, 8388608
    s_mov_b32 s39, 0x20000
    s_barrier
    buffer_load_dwordx4 v[224:227], v1, s[32:35], s82 offen offset:0 nt
    buffer_load_dwordx4 v[228:231], v1, s[32:35], s82 offen offset:64 nt
    buffer_load_dwordx4 v[232:235], v1, s[32:35], s82 offen offset:128 nt
    buffer_load_dwordx4 v[236:239], v1, s[32:35], s82 offen offset:192 nt
    buffer_load_dwordx4 v[240:243], v2, s[36:39], s82 offen offset:0 nt
    buffer_load_dwordx4 v[244:247], v2, s[36:39], s82 offen offset:256 nt
    buffer_load_dwordx4 v[248:251], v2, s[36:39], s82 offen offset:512 nt
    buffer_load_dwordx4 v[252:255], v2, s[36:39], s82 offen offset:768 nt
    s_add_u32 s82, s82, 28672
    s_load_dword s80, s[28:29], 0
    s_mov_b32 s40, s28
    s_and_b32 s41, s29, 0xffff
    s_mov_b32 s42, 2097152
    s_mov_b32 s43, 0x20000
    s_mov_b32 s72, s20
    s_and_b32 s73, s21, 0xffff
    s_mov_b32 s74, 5308416
    s_mov_b32 s75, 0x20000
    s_mov_b32 s44, s4
    s_and_b32 s45, s5, 0xffff
    s_mov_b32 s46, 1152
    s_mov_b32 s47, 0x20000
    s_mov_b32 s76, s26
    s_and_b32 s77, s27, 0xffff
    s_mov_b32 s78, 1152
    s_mov_b32 s79, 0x20000
    s_cmp_lt_u32 s81, 4
    s_cbranch_scc0 L_gu_up
    s_mov_b32 s64, s16
    s_and_b32 s65, s17, 0xffff
    s_mov_b32 s66, 5308416
    s_mov_b32 s67, 0x20000
    s_branch L_gu_done
L_gu_up:
    s_mov_b32 s64, s18
    s_and_b32 s65, s19, 0xffff
    s_mov_b32 s66, 5308416
    s_mov_b32 s67, 0x20000
L_gu_done:
    v_bfe_u32 v36, v0, 3, 1
    v_lshrrev_b32 v37, 4, v0
    v_lshl_add_u32 v36, v36, 2, v37
    v_and_b32 v37, 7, v0
    v_lshlrev_b32 v37, 4, v37
    v_mul_u32_u24 v60, 9216, v36
    v_add_u32 v60, v60, v37
    v_mul_u32_u24 v61, 1152, v36
    v_add_u32 v61, v61, v37
    s_and_b32 s92, s81, 3
    s_mul_i32 s52, s92, 1327104
    s_lshl_b32 s92, s90, 7
    s_add_u32 s52, s52, s92
    s_mul_i32 s53, s90, 73728
    s_lshl_b32 s92, s81, 7
    s_add_u32 s53, s53, s92
    s_mov_b32 s54, 0x800000
    s_mov_b32 s48, 0
    s_mov_b32 s49, 0
    s_mov_b32 s57, 0
    s_mov_b32 s58, 15
    s_mov_b32 s56, 96
    s_mov_b32 s59, 2
    s_cmp_eq_u32 s89, 0
    s_cselect_b32 s59, 2, s59
    s_cmp_ge_u32 s81, 4
    s_cselect_b32 s59, 2, 0
    s_cmp_eq_u32 s89, 0
    s_cselect_b32 s59, 0, s59
    s_waitcnt lgkmcnt(0)
    s_mul_i32 s80, s80, 0x9E3779B1
    s_add_u32 s80, s80, 0x7F4A7C15
    s_waitcnt vmcnt(4)
    buffer_load_dwordx4 v[64:67], v1, s[32:35], s82 offen offset:0 nt
    buffer_load_dwordx4 v[68:71], v1, s[32:35], s82 offen offset:64 nt
    buffer_load_dwordx4 v[72:75], v1, s[32:35], s82 offen offset:128 nt
    buffer_load_dwordx4 v[76:79], v1, s[32:35], s82 offen offset:192 nt
    buffer_load_dwordx4 v[80:83], v2, s[36:39], s82 offen offset:0 nt
    buffer_load_dwordx4 v[84:87], v2, s[36:39], s82 offen offset:256 nt
    buffer_load_dwordx4 v[88:91], v2, s[36:39], s82 offen offset:512 nt
    buffer_load_dwordx4 v[92:95], v2, s[36:39], s82 offen offset:768 nt
    s_add_u32 s82, s82, 28672
    s_waitcnt vmcnt(4)
    buffer_load_dwordx4 v[96:99], v1, s[32:35], s82 offen offset:0 nt
    buffer_load_dwordx4 v[100:103], v1, s[32:35], s82 offen offset:64 nt
    buffer_load_dwordx4 v[104:107], v1, s[32:35], s82 offen offset:128 nt
    buffer_load_dwordx4 v[108:111], v1, s[32:35], s82 offen offset:192 nt
    buffer_load_dwordx4 v[112:115], v2, s[36:39], s82 offen offset:0 nt
    buffer_load_dwordx4 v[116:119], v2, s[36:39], s82 offen offset:256 nt
    buffer_load_dwordx4 v[120:123], v2, s[36:39], s82 offen offset:512 nt
    buffer_load_dwordx4 v[124:127], v2, s[36:39], s82 offen offset:768 nt
    s_add_u32 s82, s82, 28672
    s_waitcnt vmcnt(4)
    buffer_load_dwordx4 v[128:131], v1, s[32:35], s82 offen offset:0 nt
    buffer_load_dwordx4 v[132:135], v1, s[32:35], s82 offen offset:64 nt
    buffer_load_dwordx4 v[136:139], v1, s[32:35], s82 offen offset:128 nt
    buffer_load_dwordx4 v[140:143], v1, s[32:35], s82 offen offset:192 nt
    buffer_load_dwordx4 v[144:147], v2, s[36:39], s82 offen offset:0 nt
    buffer_load_dwordx4 v[148:151], v2, s[36:39], s82 offen offset:256 nt
    buffer_load_dwordx4 v[152:155], v2, s[36:39], s82 offen offset:512 nt
    buffer_load_dwordx4 v[156:159], v2, s[36:39], s82 offen offset:768 nt
    s_add_u32 s82, s82, 28672
    s_waitcnt vmcnt(4)
    buffer_load_dwordx4 v[160:163], v1, s[32:35], s82 offen offset:0 nt
    buffer_load_dwordx4 v[164:167], v1, s[32:35], s82 offen offset:64 nt
    buffer_load_dwordx4 v[168:171], v1, s[32:35], s82 offen offset:128 nt
    buffer_load_dwordx4 v[172:175], v1, s[32:35], s82 offen offset:192 nt
    buffer_load_dwordx4 v[176:179], v2, s[36:39], s82 offen offset:0 nt
    buffer_load_dwordx4 v[180:183], v2, s[36:39], s82 offen offset:256 nt
    buffer_load_dwordx4 v[184:187], v2, s[36:39], s82 offen offset:512 nt
    buffer_load_dwordx4 v[188:191], v2, s[36:39], s82 offen offset:768 nt
    s_add_u32 s82, s82, 28672
    s_waitcnt vmcnt(4)
    buffer_load_dwordx4 v[192:195], v1, s[32:35], s82 offen offset:0 nt
    buffer_load_dwordx4 v[196:199], v1, s[32:35], s82 offen offset:64 nt
    buffer_load_dwordx4 v[200:203], v1, s[32:35], s82 offen offset:128 nt
    buffer_load_dwordx4 v[204:207], v1, s[32:35], s82 offen offset:192 nt
    buffer_load_dwordx4 v[208:211], v2, s[36:39], s82 offen offset:0 nt
    buffer_load_dwordx4 v[212:215], v2, s[36:39], s82 offen offset:256 nt
    buffer_load_dwordx4 v[216:219], v2, s[36:39], s82 offen offset:512 nt
    buffer_load_dwordx4 v[220:223], v2, s[36:39], s82 offen offset:768 nt
    s_add_u32 s82, s82, 28672
    s_mov_b32 s83, 200000
L_qfl:
    ds_read_b32 v36, v14 offset:2604
    s_waitcnt lgkmcnt(0)
    v_readfirstlane_b32 s30, v36
    s_cmp_eq_u32 s30, 1
    s_cbranch_scc1 L_qfl_ok
    s_sub_u32 s83, s83, 1
    s_cmp_lg_u32 s83, 0
    s_nop 0
    s_cbranch_scc1 L_qfl
L_qfl_ok:
    s_mov_b64 exec, 1
    ds_add_rtn_u32 v13, v14, v15 offset:2592
    s_mov_b64 exec, -1
    ds_read_b128 v[44:47], v3 offset:0
    ds_read_b128 v[48:51], v3 offset:64
    ds_read_b128 v[52:55], v3 offset:128
    ds_read_b128 v[56:59], v3 offset:192
    s_mov_b32 s51, 0
    s_waitcnt lgkmcnt(0)
    v_readfirstlane_b32 s30, v13
    v_mfma_f32_16x16x32_bf16 v[16:19], v[224:227], v[44:47], 0
    v_mfma_f32_16x16x32_bf16 v[16:19], v[228:231], v[48:51], v[16:19]
    v_mfma_f32_16x16x32_bf16 v[16:19], v[232:235], v[52:55], v[16:19]
    v_mfma_f32_16x16x32_bf16 v[16:19], v[236:239], v[56:59], v[16:19]
    s_nop 7
    v_cvt_pk_bf16_f32 v16, 0, v16
    v_cvt_pk_bf16_f32 v17, 0, v17
    v_cvt_pk_bf16_f32 v18, 0, v18
    v_cvt_pk_bf16_f32 v19, 0, v19
    v_pk_mul_f32 v[16:17], v[16:17], s[84:85]
    v_pk_mul_f32 v[18:19], v[18:19], s[84:85]
    v_cvt_pk_bf16_f32 v16, 0, v16
    v_cvt_pk_bf16_f32 v17, 0, v17
    v_cvt_pk_bf16_f32 v18, 0, v18
    v_cvt_pk_bf16_f32 v19, 0, v19
    v_max3_f32 v36, v16, v17, v18
    v_max_f32 v36, v36, v19
    v_mov_b32 v37, v36
    s_nop 1
    v_permlane16_swap_b32 v36, v37
    v_max_f32 v36, v36, v37
    v_mov_b32 v37, v36
    s_nop 1
    v_permlane32_swap_b32 v36, v37
    v_max_f32 v36, v36, v37
    v_mul_f32 v36, s86, v36
    v_max_f32 v36, v10, v36
    v_sub_f32 v12, v10, v36
    v_exp_f32 v12, v12
    v_mov_b32 v10, v36
    v_fma_f32 v32, v16, s86, -v36
    v_fma_f32 v33, v17, s86, -v36
    v_fma_f32 v34, v18, s86, -v36
    v_fma_f32 v35, v19, s86, -v36
    v_exp_f32 v32, v32
    v_exp_f32 v33, v33
    v_exp_f32 v34, v34
    v_exp_f32 v35, v35
    v_pk_mul_f32 v[8:9], v[8:9], v[12:13] op_sel_hi:[1,0]
    v_pk_mul_f32 v[20:21], v[20:21], v[12:13] op_sel_hi:[1,0]
    v_pk_mul_f32 v[22:23], v[22:23], v[12:13] op_sel_hi:[1,0]
    v_pk_add_f32 v[8:9], v[8:9], v[32:33]
    v_pk_add_f32 v[8:9], v[8:9], v[34:35]
    v_cvt_pk_bf16_f32 v38, v32, v32
    v_and_b32 v24, v38, v4
    v_and_b32 v25, v38, v5
    v_and_b32 v26, v38, v6
    v_and_b32 v27, v38, v7
    s_nop 1
    v_mfma_f32_16x16x32_bf16 v[20:23], v[240:243], v[24:27], v[20:23]
    v_cvt_pk_bf16_f32 v39, v33, v33
    v_and_b32 v28, v39, v4
    v_and_b32 v29, v39, v5
    v_and_b32 v30, v39, v6
    v_and_b32 v31, v39, v7
    s_nop 1
    v_mfma_f32_16x16x32_bf16 v[20:23], v[244:247], v[28:31], v[20:23]
    v_cvt_pk_bf16_f32 v40, v34, v34
    v_and_b32 v24, v40, v4
    v_and_b32 v25, v40, v5
    v_and_b32 v26, v40, v6
    v_and_b32 v27, v40, v7
    s_nop 1
    v_mfma_f32_16x16x32_bf16 v[20:23], v[248:251], v[24:27], v[20:23]
    v_cvt_pk_bf16_f32 v41, v35, v35
    v_and_b32 v28, v41, v4
    v_and_b32 v29, v41, v5
    v_and_b32 v30, v41, v6
    v_and_b32 v31, v41, v7
    s_nop 1
    v_mfma_f32_16x16x32_bf16 v[20:23], v[252:255], v[28:31], v[20:23]
    v_mfma_f32_16x16x32_bf16 v[16:19], v[64:67], v[44:47], 0
    v_mfma_f32_16x16x32_bf16 v[16:19], v[68:71], v[48:51], v[16:19]
    v_mfma_f32_16x16x32_bf16 v[16:19], v[72:75], v[52:55], v[16:19]
    v_mfma_f32_16x16x32_bf16 v[16:19], v[76:79], v[56:59], v[16:19]
    s_nop 7
    v_cvt_pk_bf16_f32 v16, 0, v16
    v_cvt_pk_bf16_f32 v17, 0, v17
    v_cvt_pk_bf16_f32 v18, 0, v18
    v_cvt_pk_bf16_f32 v19, 0, v19
    v_pk_mul_f32 v[16:17], v[16:17], s[84:85]
    v_pk_mul_f32 v[18:19], v[18:19], s[84:85]
    v_cvt_pk_bf16_f32 v16, 0, v16
    v_cvt_pk_bf16_f32 v17, 0, v17
    v_cvt_pk_bf16_f32 v18, 0, v18
    v_cvt_pk_bf16_f32 v19, 0, v19
    v_max3_f32 v36, v16, v17, v18
    v_max_f32 v36, v36, v19
    v_mov_b32 v37, v36
    s_nop 1
    v_permlane16_swap_b32 v36, v37
    v_max_f32 v36, v36, v37
    v_mov_b32 v37, v36
    s_nop 1
    v_permlane32_swap_b32 v36, v37
    v_max_f32 v36, v36, v37
    v_mul_f32 v36, s86, v36
    v_max_f32 v36, v10, v36
    v_sub_f32 v12, v10, v36
    v_exp_f32 v12, v12
    v_mov_b32 v10, v36
    v_fma_f32 v32, v16, s86, -v36
    v_fma_f32 v33, v17, s86, -v36
    v_fma_f32 v34, v18, s86, -v36
    v_fma_f32 v35, v19, s86, -v36
    v_exp_f32 v32, v32
    v_exp_f32 v33, v33
    v_exp_f32 v34, v34
    v_exp_f32 v35, v35
    v_pk_mul_f32 v[8:9], v[8:9], v[12:13] op_sel_hi:[1,0]
    v_pk_mul_f32 v[20:21], v[20:21], v[12:13] op_sel_hi:[1,0]
    v_pk_mul_f32 v[22:23], v[22:23], v[12:13] op_sel_hi:[1,0]
    v_pk_add_f32 v[8:9], v[8:9], v[32:33]
    v_pk_add_f32 v[8:9], v[8:9], v[34:35]
    v_cvt_pk_bf16_f32 v38, v32, v32
    v_and_b32 v24, v38, v4
    v_and_b32 v25, v38, v5
    v_and_b32 v26, v38, v6
    v_and_b32 v27, v38, v7
    s_nop 1
    v_mfma_f32_16x16x32_bf16 v[20:23], v[80:83], v[24:27], v[20:23]
    v_cvt_pk_bf16_f32 v39, v33, v33
    v_and_b32 v28, v39, v4
    v_and_b32 v29, v39, v5
    v_and_b32 v30, v39, v6
    v_and_b32 v31, v39, v7
    s_nop 1
    v_mfma_f32_16x16x32_bf16 v[20:23], v[84:87], v[28:31], v[20:23]
    v_cvt_pk_bf16_f32 v40, v34, v34
    v_and_b32 v24, v40, v4
    v_and_b32 v25, v40, v5
    v_and_b32 v26, v40, v6
    v_and_b32 v27, v40, v7
    s_nop 1
    v_mfma_f32_16x16x32_bf16 v[20:23], v[88:91], v[24:27], v[20:23]
    v_cvt_pk_bf16_f32 v41, v35, v35
    v_and_b32 v28, v41, v4
    v_and_b32 v29, v41, v5
    v_and_b32 v30, v41, v6
    v_and_b32 v31, v41, v7
    s_nop 1
    v_mfma_f32_16x16x32_bf16 v[20:23], v[92:95], v[28:31], v[20:23]
    v_mfma_f32_16x16x32_bf16 v[16:19], v[96:99], v[44:47], 0
    v_mfma_f32_16x16x32_bf16 v[16:19], v[100:103], v[48:51], v[16:19]
    v_mfma_f32_16x16x32_bf16 v[16:19], v[104:107], v[52:55], v[16:19]
    v_mfma_f32_16x16x32_bf16 v[16:19], v[108:111], v[56:59], v[16:19]
    s_nop 7
    v_cvt_pk_bf16_f32 v16, 0, v16
    v_cvt_pk_bf16_f32 v17, 0, v17
    v_cvt_pk_bf16_f32 v18, 0, v18
    v_cvt_pk_bf16_f32 v19, 0, v19
    v_pk_mul_f32 v[16:17], v[16:17], s[84:85]
    v_pk_mul_f32 v[18:19], v[18:19], s[84:85]
    v_cvt_pk_bf16_f32 v16, 0, v16
    v_cvt_pk_bf16_f32 v17, 0, v17
    v_cvt_pk_bf16_f32 v18, 0, v18
    v_cvt_pk_bf16_f32 v19, 0, v19
    v_max3_f32 v36, v16, v17, v18
    v_max_f32 v36, v36, v19
    v_mov_b32 v37, v36
    s_nop 1
    v_permlane16_swap_b32 v36, v37
    v_max_f32 v36, v36, v37
    v_mov_b32 v37, v36
    s_nop 1
    v_permlane32_swap_b32 v36, v37
    v_max_f32 v36, v36, v37
    v_mul_f32 v36, s86, v36
    v_max_f32 v36, v10, v36
    v_sub_f32 v12, v10, v36
    v_exp_f32 v12, v12
    v_mov_b32 v10, v36
    v_fma_f32 v32, v16, s86, -v36
    v_fma_f32 v33, v17, s86, -v36
    v_fma_f32 v34, v18, s86, -v36
    v_fma_f32 v35, v19, s86, -v36
    v_exp_f32 v32, v32
    v_exp_f32 v33, v33
    v_exp_f32 v34, v34
    v_exp_f32 v35, v35
    v_pk_mul_f32 v[8:9], v[8:9], v[12:13] op_sel_hi:[1,0]
    v_pk_mul_f32 v[20:21], v[20:21], v[12:13] op_sel_hi:[1,0]
    v_pk_mul_f32 v[22:23], v[22:23], v[12:13] op_sel_hi:[1,0]
    v_pk_add_f32 v[8:9], v[8:9], v[32:33]
    v_pk_add_f32 v[8:9], v[8:9], v[34:35]
    v_cvt_pk_bf16_f32 v38, v32, v32
    v_and_b32 v24, v38, v4
    v_and_b32 v25, v38, v5
    v_and_b32 v26, v38, v6
    v_and_b32 v27, v38, v7
    s_nop 1
    v_mfma_f32_16x16x32_bf16 v[20:23], v[112:115], v[24:27], v[20:23]
    v_cvt_pk_bf16_f32 v39, v33, v33
    v_and_b32 v28, v39, v4
    v_and_b32 v29, v39, v5
    v_and_b32 v30, v39, v6
    v_and_b32 v31, v39, v7
    s_nop 1
    v_mfma_f32_16x16x32_bf16 v[20:23], v[116:119], v[28:31], v[20:23]
    v_cvt_pk_bf16_f32 v40, v34, v34
    v_and_b32 v24, v40, v4
    v_and_b32 v25, v40, v5
    v_and_b32 v26, v40, v6
    v_and_b32 v27, v40, v7
    s_nop 1
    v_mfma_f32_16x16x32_bf16 v[20:23], v[120:123], v[24:27], v[20:23]
    v_cvt_pk_bf16_f32 v41, v35, v35
    v_and_b32 v28, v41, v4
    v_and_b32 v29, v41, v5
    v_and_b32 v30, v41, v6
    v_and_b32 v31, v41, v7
    s_nop 1
    v_mfma_f32_16x16x32_bf16 v[20:23], v[124:127], v[28:31], v[20:23]
    s_cmp_ge_u32 s30, s56
    s_nop 6
    s_cbranch_scc1 L_cu_late
    s_lshl_b32 s82, s30, 12
    s_add_u32 s82, s82, s55
    s_waitcnt vmcnt(4)
    buffer_load_dwordx4 v[224:227], v1, s[32:35], s82 offen offset:0 nt
    buffer_load_dwordx4 v[228:231], v1, s[32:35], s82 offen offset:64 nt
    buffer_load_dwordx4 v[232:235], v1, s[32:35], s82 offen offset:128 nt
    buffer_load_dwordx4 v[236:239], v1, s[32:35], s82 offen offset:192 nt
    buffer_load_dwordx4 v[240:243], v2, s[36:39], s82 offen offset:0 nt
    buffer_load_dwordx4 v[244:247], v2, s[36:39], s82 offen offset:256 nt
    buffer_load_dwordx4 v[248:251], v2, s[36:39], s82 offen offset:512 nt
    buffer_load_dwordx4 v[252:255], v2, s[36:39], s82 offen offset:768 nt
L_cu_cont:
    v_mfma_f32_16x16x32_bf16 v[16:19], v[128:131], v[44:47], 0
    v_mfma_f32_16x16x32_bf16 v[16:19], v[132:135], v[48:51], v[16:19]
    v_mfma_f32_16x16x32_bf16 v[16:19], v[136:139], v[52:55], v[16:19]
    v_mfma_f32_16x16x32_bf16 v[16:19], v[140:143], v[56:59], v[16:19]
    s_nop 7
    v_cvt_pk_bf16_f32 v16, 0, v16
    v_cvt_pk_bf16_f32 v17, 0, v17
    v_cvt_pk_bf16_f32 v18, 0, v18
    v_cvt_pk_bf16_f32 v19, 0, v19
    v_pk_mul_f32 v[16:17], v[16:17], s[84:85]
    v_pk_mul_f32 v[18:19], v[18:19], s[84:85]
    v_cvt_pk_bf16_f32 v16, 0, v16
    v_cvt_pk_bf16_f32 v17, 0, v17
    v_cvt_pk_bf16_f32 v18, 0, v18
    v_cvt_pk_bf16_f32 v19, 0, v19
    v_max3_f32 v36, v16, v17, v18
    v_max_f32 v36, v36, v19
    v_mov_b32 v37, v36
    s_nop 1
    v_permlane16_swap_b32 v36, v37
    v_max_f32 v36, v36, v37
    v_mov_b32 v37, v36
    s_nop 1
    v_permlane32_swap_b32 v36, v37
    v_max_f32 v36, v36, v37
    v_mul_f32 v36, s86, v36
    v_max_f32 v36, v10, v36
    v_sub_f32 v12, v10, v36
    v_exp_f32 v12, v12
    v_mov_b32 v10, v36
    v_fma_f32 v32, v16, s86, -v36
    v_fma_f32 v33, v17, s86, -v36
    v_fma_f32 v34, v18, s86, -v36
    v_fma_f32 v35, v19, s86, -v36
    v_exp_f32 v32, v32
    v_exp_f32 v33, v33
    v_exp_f32 v34, v34
    v_exp_f32 v35, v35
    v_pk_mul_f32 v[8:9], v[8:9], v[12:13] op_sel_hi:[1,0]
    v_pk_mul_f32 v[20:21], v[20:21], v[12:13] op_sel_hi:[1,0]
    v_pk_mul_f32 v[22:23], v[22:23], v[12:13] op_sel_hi:[1,0]
    v_pk_add_f32 v[8:9], v[8:9], v[32:33]
    v_pk_add_f32 v[8:9], v[8:9], v[34:35]
    v_cvt_pk_bf16_f32 v38, v32, v32
    v_and_b32 v24, v38, v4
    v_and_b32 v25, v38, v5
    v_and_b32 v26, v38, v6
    v_and_b32 v27, v38, v7
    s_nop 1
    v_mfma_f32_16x16x32_bf16 v[20:23], v[144:147], v[24:27], v[20:23]
    v_cvt_pk_bf16_f32 v39, v33, v33
    v_and_b32 v28, v39, v4
    v_and_b32 v29, v39, v5
    v_and_b32 v30, v39, v6
    v_and_b32 v31, v39, v7
    s_nop 1
    v_mfma_f32_16x16x32_bf16 v[20:23], v[148:151], v[28:31], v[20:23]
    v_cvt_pk_bf16_f32 v40, v34, v34
    v_and_b32 v24, v40, v4
    v_and_b32 v25, v40, v5
    v_and_b32 v26, v40, v6
    v_and_b32 v27, v40, v7
    s_nop 1
    v_mfma_f32_16x16x32_bf16 v[20:23], v[152:155], v[24:27], v[20:23]
    v_cvt_pk_bf16_f32 v41, v35, v35
    v_and_b32 v28, v41, v4
    v_and_b32 v29, v41, v5
    v_and_b32 v30, v41, v6
    v_and_b32 v31, v41, v7
    s_nop 1
    v_mfma_f32_16x16x32_bf16 v[20:23], v[156:159], v[28:31], v[20:23]
    v_mfma_f32_16x16x32_bf16 v[16:19], v[160:163], v[44:47], 0
    v_mfma_f32_16x16x32_bf16 v[16:19], v[164:167], v[48:51], v[16:19]
    v_mfma_f32_16x16x32_bf16 v[16:19], v[168:171], v[52:55], v[16:19]
    v_mfma_f32_16x16x32_bf16 v[16:19], v[172:175], v[56:59], v[16:19]
    s_nop 7
    v_cvt_pk_bf16_f32 v16, 0, v16
    v_cvt_pk_bf16_f32 v17, 0, v17
    v_cvt_pk_bf16_f32 v18, 0, v18
    v_cvt_pk_bf16_f32 v19, 0, v19
    v_pk_mul_f32 v[16:17], v[16:17], s[84:85]
    v_pk_mul_f32 v[18:19], v[18:19], s[84:85]
    v_cvt_pk_bf16_f32 v16, 0, v16
    v_cvt_pk_bf16_f32 v17, 0, v17
    v_cvt_pk_bf16_f32 v18, 0, v18
    v_cvt_pk_bf16_f32 v19, 0, v19
    v_max3_f32 v36, v16, v17, v18
    v_max_f32 v36, v36, v19
    v_mov_b32 v37, v36
    s_nop 1
    v_permlane16_swap_b32 v36, v37
    v_max_f32 v36, v36, v37
    v_mov_b32 v37, v36
    s_nop 1
    v_permlane32_swap_b32 v36, v37
    v_max_f32 v36, v36, v37
    v_mul_f32 v36, s86, v36
    v_max_f32 v36, v10, v36
    v_sub_f32 v12, v10, v36
    v_exp_f32 v12, v12
    v_mov_b32 v10, v36
    v_fma_f32 v32, v16, s86, -v36
    v_fma_f32 v33, v17, s86, -v36
    v_fma_f32 v34, v18, s86, -v36
    v_fma_f32 v35, v19, s86, -v36
    v_exp_f32 v32, v32
    v_exp_f32 v33, v33
    v_exp_f32 v34, v34
    v_exp_f32 v35, v35
    v_pk_mul_f32 v[8:9], v[8:9], v[12:13] op_sel_hi:[1,0]
    v_pk_mul_f32 v[20:21], v[20:21], v[12:13] op_sel_hi:[1,0]
    v_pk_mul_f32 v[22:23], v[22:23], v[12:13] op_sel_hi:[1,0]
    v_pk_add_f32 v[8:9], v[8:9], v[32:33]
    v_pk_add_f32 v[8:9], v[8:9], v[34:35]
    v_cvt_pk_bf16_f32 v38, v32, v32
    v_and_b32 v24, v38, v4
    v_and_b32 v25, v38, v5
    v_and_b32 v26, v38, v6
    v_and_b32 v27, v38, v7
    s_nop 1
    v_mfma_f32_16x16x32_bf16 v[20:23], v[176:179], v[24:27], v[20:23]
    v_cvt_pk_bf16_f32 v39, v33, v33
    v_and_b32 v28, v39, v4
    v_and_b32 v29, v39, v5
    v_and_b32 v30, v39, v6
    v_and_b32 v31, v39, v7
    s_nop 1
    v_mfma_f32_16x16x32_bf16 v[20:23], v[180:183], v[28:31], v[20:23]
    v_cvt_pk_bf16_f32 v40, v34, v34
    v_and_b32 v24, v40, v4
    v_and_b32 v25, v40, v5
    v_and_b32 v26, v40, v6
    v_and_b32 v27, v40, v7
    s_nop 1
    v_mfma_f32_16x16x32_bf16 v[20:23], v[184:187], v[24:27], v[20:23]
    v_cvt_pk_bf16_f32 v41, v35, v35
    v_and_b32 v28, v41, v4
    v_and_b32 v29, v41, v5
    v_and_b32 v30, v41, v6
    v_and_b32 v31, v41, v7
    s_nop 1
    v_mfma_f32_16x16x32_bf16 v[20:23], v[188:191], v[28:31], v[20:23]
    v_mfma_f32_16x16x32_bf16 v[16:19], v[192:195], v[44:47], 0
    v_mfma_f32_16x16x32_bf16 v[16:19], v[196:199], v[48:51], v[16:19]
    v_mfma_f32_16x16x32_bf16 v[16:19], v[200:203], v[52:55], v[16:19]
    v_mfma_f32_16x16x32_bf16 v[16:19], v[204:207], v[56:59], v[16:19]
    s_nop 7
    v_cvt_pk_bf16_f32 v16, 0, v16
    v_cvt_pk_bf16_f32 v17, 0, v17
    v_cvt_pk_bf16_f32 v18, 0, v18
    v_cvt_pk_bf16_f32 v19, 0, v19
    v_pk_mul_f32 v[16:17], v[16:17], s[84:85]
    v_pk_mul_f32 v[18:19], v[18:19], s[84:85]
    v_cvt_pk_bf16_f32 v16, 0, v16
    v_cvt_pk_bf16_f32 v17, 0, v17
    v_cvt_pk_bf16_f32 v18, 0, v18
    v_cvt_pk_bf16_f32 v19, 0, v19
    v_max3_f32 v36, v16, v17, v18
    v_max_f32 v36, v36, v19
    v_mov_b32 v37, v36
    s_nop 1
    v_permlane16_swap_b32 v36, v37
    v_max_f32 v36, v36, v37
    v_mov_b32 v37, v36
    s_nop 1
    v_permlane32_swap_b32 v36, v37
    v_max_f32 v36, v36, v37
    v_mul_f32 v36, s86, v36
    v_max_f32 v36, v10, v36
    v_sub_f32 v12, v10, v36
    v_exp_f32 v12, v12
    v_mov_b32 v10, v36
    v_fma_f32 v32, v16, s86, -v36
    v_fma_f32 v33, v17, s86, -v36
    v_fma_f32 v34, v18, s86, -v36
    v_fma_f32 v35, v19, s86, -v36
    v_exp_f32 v32, v32
    v_exp_f32 v33, v33
    v_exp_f32 v34, v34
    v_exp_f32 v35, v35
    v_pk_mul_f32 v[8:9], v[8:9], v[12:13] op_sel_hi:[1,0]
    v_pk_mul_f32 v[20:21], v[20:21], v[12:13] op_sel_hi:[1,0]
    v_pk_mul_f32 v[22:23], v[22:23], v[12:13] op_sel_hi:[1,0]
    v_pk_add_f32 v[8:9], v[8:9], v[32:33]
    v_pk_add_f32 v[8:9], v[8:9], v[34:35]
    v_cvt_pk_bf16_f32 v38, v32, v32
    v_and_b32 v24, v38, v4
    v_and_b32 v25, v38, v5
    v_and_b32 v26, v38, v6
    v_and_b32 v27, v38, v7
    s_waitcnt vmcnt(8)
    s_nop 0
    v_mfma_f32_16x16x32_bf16 v[20:23], v[208:211], v[24:27], v[20:23]
    v_cvt_pk_bf16_f32 v39, v33, v33
    v_and_b32 v28, v39, v4
    v_and_b32 v29, v39, v5
    v_and_b32 v30, v39, v6
    v_and_b32 v31, v39, v7
    s_nop 1
    v_mfma_f32_16x16x32_bf16 v[20:23], v[212:215], v[28:31], v[20:23]
    v_cvt_pk_bf16_f32 v40, v34, v34
    v_and_b32 v24, v40, v4
    v_and_b32 v25, v40, v5
    v_and_b32 v26, v40, v6
    v_and_b32 v27, v40, v7
    s_nop 1
    v_mfma_f32_16x16x32_bf16 v[20:23], v[216:219], v[24:27], v[20:23]
    v_cvt_pk_bf16_f32 v41, v35, v35
    v_and_b32 v28, v41, v4
    v_and_b32 v29, v41, v5
    v_and_b32 v30, v41, v6
    v_and_b32 v31, v41, v7
    s_nop 1
    v_mfma_f32_16x16x32_bf16 v[20:23], v[220:223], v[28:31], v[20:23]
    s_cmp_lg_u32 s51, 0
    s_nop 6
    s_cbranch_scc1 L_bend
L_loop:
    s_mov_b64 exec, 1
    ds_add_rtn_u32 v13, v14, v15 offset:2592
    s_mov_b64 exec, -1
    s_waitcnt vmcnt(4)
    v_mfma_f32_16x16x32_bf16 v[16:19], v[224:227], v[44:47], 0
    v_mfma_f32_16x16x32_bf16 v[16:19], v[228:231], v[48:51], v[16:19]
    v_mfma_f32_16x16x32_bf16 v[16:19], v[232:235], v[52:55], v[16:19]
    v_mfma_f32_16x16x32_bf16 v[16:19], v[236:239], v[56:59], v[16:19]
    s_nop 7
    v_cvt_pk_bf16_f32 v16, 0, v16
    v_cvt_pk_bf16_f32 v17, 0, v17
    v_cvt_pk_bf16_f32 v18, 0, v18
    v_cvt_pk_bf16_f32 v19, 0, v19
    v_pk_mul_f32 v[16:17], v[16:17], s[84:85]
    v_pk_mul_f32 v[18:19], v[18:19], s[84:85]
    v_cvt_pk_bf16_f32 v16, 0, v16
    v_cvt_pk_bf16_f32 v17, 0, v17
    v_cvt_pk_bf16_f32 v18, 0, v18
    v_cvt_pk_bf16_f32 v19, 0, v19
    v_max3_f32 v36, v16, v17, v18
    v_max_f32 v36, v36, v19
    v_mov_b32 v37, v36
    s_nop 1
    v_permlane16_swap_b32 v36, v37
    v_max_f32 v36, v36, v37
    v_mov_b32 v37, v36
    s_nop 1
    v_permlane32_swap_b32 v36, v37
    v_max_f32 v36, v36, v37
    v_mul_f32 v36, s86, v36
    v_max_f32 v36, v10, v36
    v_sub_f32 v12, v10, v36
    v_exp_f32 v12, v12
    v_mov_b32 v10, v36
    v_fma_f32 v32, v16, s86, -v36
    v_fma_f32 v33, v17, s86, -v36
    v_fma_f32 v34, v18, s86, -v36
    v_fma_f32 v35, v19, s86, -v36
    v_exp_f32 v32, v32
    v_exp_f32 v33, v33
    v_exp_f32 v34, v34
    v_exp_f32 v35, v35
    v_pk_mul_f32 v[8:9], v[8:9], v[12:13] op_sel_hi:[1,0]
    v_pk_mul_f32 v[20:21], v[20:21], v[12:13] op_sel_hi:[1,0]
    v_pk_mul_f32 v[22:23], v[22:23], v[12:13] op_sel_hi:[1,0]
    v_pk_add_f32 v[8:9], v[8:9], v[32:33]
    v_pk_add_f32 v[8:9], v[8:9], v[34:35]
    v_cvt_pk_bf16_f32 v38, v32, v32
    v_and_b32 v24, v38, v4
    v_and_b32 v25, v38, v5
    v_and_b32 v26, v38, v6
    v_and_b32 v27, v38, v7
    s_waitcnt vmcnt(0)
    s_nop 0
    v_mfma_f32_16x16x32_bf16 v[20:23], v[240:243], v[24:27], v[20:23]
    v_cvt_pk_bf16_f32 v39, v33, v33
    v_and_b32 v28, v39, v4
    v_and_b32 v29, v39, v5
    v_and_b32 v30, v39, v6
    v_and_b32 v31, v39, v7
    s_nop 1
    v_mfma_f32_16x16x32_bf16 v[20:23], v[244:247], v[28:31], v[20:23]
    v_cvt_pk_bf16_f32 v40, v34, v34
    v_and_b32 v24, v40, v4
    v_and_b32 v25, v40, v5
    v_and_b32 v26, v40, v6
    v_and_b32 v27, v40, v7
    s_nop 1
    v_mfma_f32_16x16x32_bf16 v[20:23], v[248:251], v[24:27], v[20:23]
    v_cvt_pk_bf16_f32 v41, v35, v35
    v_and_b32 v28, v41, v4
    v_and_b32 v29, v41, v5
    v_and_b32 v30, v41, v6
    v_and_b32 v31, v41, v7
    s_nop 1
    v_mfma_f32_16x16x32_bf16 v[20:23], v[252:255], v[28:31], v[20:23]
    s_nop 7
L_bend:
    s_waitcnt lgkmcnt(0)
    v_readfirstlane_b32 s30, v13
    s_cmp_ge_u32 s30, s56
    s_nop 3
    s_cbranch_scc1 L_slow
    s_lshl_b32 s82, s30, 12
    s_add_u32 s82, s82, s55
L_kv:
    buffer_load_dwordx4 v[224:227], v1, s[32:35], s82 offen offset:0 nt
    buffer_load_dwordx4 v[228:231], v1, s[32:35], s82 offen offset:64 nt
    buffer_load_dwordx4 v[232:235], v1, s[32:35], s82 offen offset:128 nt
    buffer_load_dwordx4 v[236:239], v1, s[32:35], s82 offen offset:192 nt
    buffer_load_dwordx4 v[240:243], v2, s[36:39], s82 offen offset:0 nt
    buffer_load_dwordx4 v[244:247], v2, s[36:39], s82 offen offset:256 nt
    buffer_load_dwordx4 v[248:251], v2, s[36:39], s82 offen offset:512 nt
    buffer_load_dwordx4 v[252:255], v2, s[36:39], s82 offen offset:768 nt
    s_branch L_loop
L_epi:
    v_add_f32 v8, v8, v9
    v_mov_b32 v36, v8
    s_nop 1
    v_permlane16_swap_b32 v8, v36
    v_add_f32 v8, v8, v36
    v_mov_b32 v36, v8
    s_nop 1
    v_permlane32_swap_b32 v8, v36
    v_add_f32 v8, v8, v36
    v_bfe_u32 v3, v0, 3, 1
    v_lshlrev_b32 v3, 9, v3
    v_lshrrev_b32 v37, 4, v0
    v_lshl_add_u32 v3, v37, 7, v3
    v_and_b32 v37, 7, v0
    v_lshl_add_u32 v3, v37, 2, v3
    s_lshl_b32 s30, s81, 10
    v_add_u32 v3, s30, v3
    ds_write_b32 v3, v20 offset:9216
    ds_write_b32 v3, v21 offset:9248
    ds_write_b32 v3, v22 offset:9280
    ds_write_b32 v3, v23 offset:9312
    v_bfe_u32 v37, v0, 3, 1
    v_lshlrev_b32 v37, 5, v37
    s_lshl_b32 s30, s81, 2
    v_add_u32 v37, s30, v37
    s_mov_b64 exec, 0x101
    ds_write_b32 v37, v10 offset:2624
    ds_write_b32 v37, v8 offset:2688
    s_mov_b64 exec, -1
    s_cmp_eq_u32 s89, 0
    s_cbranch_scc1 L_ffn_tail
    s_cmp_eq_u32 s89, 2
    s_cbranch_scc1 L_wo_tail
    s_waitcnt lgkmcnt(0)
    s_barrier
    s_endpgm
L_cu_late:
    s_mov_b32 s51, 1
    s_waitcnt vmcnt(0)
    s_branch L_cu_cont
L_slow:
    s_cmp_lg_u32 s48, 0
    s_cbranch_scc1 L_epi
    s_lshl_b32 s92, s30, 2
    v_mov_b32 v3, s92
    s_mov_b32 s93, 50000
    s_nop 0
L_spin:
    ds_read_b32 v36, v3 offset:48768
    s_waitcnt lgkmcnt(0)
    v_readfirstlane_b32 s92, v36
    s_cmp_lg_u32 s92, 0
    s_cbranch_scc1 L_got
    s_sub_u32 s93, s93, 1
    s_cmp_lg_u32 s93, 0
    s_nop 0
    s_cbranch_scc1 L_spin
    s_mov_b32 s92, 0x80000000
L_got:
    s_cmp_lt_i32 s92, 0
    s_cbranch_scc1 L_stop
    s_and_b32 s82, s92, 0x7ff000
    s_and_b32 s93, s92, s59
    s_cbranch_scc0 L_kv
    s_mov_b32 s48, 1
    s_mov_b32 s56, 0
    v_mov_b32 v15, 0
    s_nop 1
    s_branch L_kv
L_stop:
    s_branch L_epi
L_wo_tail:
    s_cmp_lt_u32 s81, 4
    s_cbranch_scc0 L_wo_c
    s_lshl_b32 s30, s81, 6
    v_add_u32 v1, s30, v0
    v_lshlrev_b32 v2, 2, v1
    v_lshrrev_b32 v8, 5, v1
    v_lshlrev_b32 v8, 6, v8
    v_bfe_u32 v9, v1, 2, 2
    v_lshl_add_u32 v8, v9, 4, v8
    v_bfe_u32 v9, v1, 4, 1
    v_lshl_add_u32 v8, v9, 3, v8
    v_and_b32 v9, 3, v1
    v_lshl_add_u32 v8, v9, 1, v8
    v_and_b32 v3, 15, v0
    v_lshlrev_b32 v3, 4, v3
    s_lshr_b32 s30, s81, 1
    s_lshl_b32 s30, s30, 3
    v_add_u32 v3, s30, v3
    s_lshl_b32 s30, s87, 14
    s_add_u32 s92, s30, 327680
    s_add_u32 s93, s92, 4096
    s_add_u32 s94, s92, 8192
    s_add_u32 s95, s92, 12288
    s_lshl_b32 s30, s87, 8
    s_add_u32 s96, s30, 126976
    s_waitcnt lgkmcnt(0)
    s_barrier
    s_barrier
    s_mov_b32 s97, 31
    s_mov_b32 s83, 50000
L_t1poll:
    s_bitcmp1_b32 s97, 0
    s_cbranch_scc0 L_t1poll_l0
    buffer_load_dwordx2 v[32:33], v3, s[40:43], s96 offen sc1
L_t1poll_l0:
    s_bitcmp1_b32 s97, 1
    s_cbranch_scc0 L_t1poll_l1
    buffer_load_dword v16, v2, s[40:43], s92 offen offset:0 sc1
    buffer_load_dword v17, v2, s[40:43], s92 offen offset:1024 sc1
    buffer_load_dword v18, v2, s[40:43], s92 offen offset:2048 sc1
    buffer_load_dword v19, v2, s[40:43], s92 offen offset:3072 sc1
L_t1poll_l1:
    s_bitcmp1_b32 s97, 2
    s_cbranch_scc0 L_t1poll_l2
    buffer_load_dword v20, v2, s[40:43], s93 offen offset:0 sc1
    buffer_load_dword v21, v2, s[40:43], s93 offen offset:1024 sc1
    buffer_load_dword v22, v2, s[40:43], s93 offen offset:2048 sc1
    buffer_load_dword v23, v2, s[40:43], s93 offen offset:3072 sc1
L_t1poll_l2:
    s_bitcmp1_b32 s97, 3
    s_cbranch_scc0 L_t1poll_l3
    buffer_load_dword v24, v2, s[40:43], s94 offen offset:0 sc1
    buffer_load_dword v25, v2, s[40:43], s94 offen offset:1024 sc1
    buffer_load_dword v26, v2, s[40:43], s94 offen offset:2048 sc1
    buffer_load_dword v27, v2, s[40:43], s94 offen offset:3072 sc1
L_t1poll_l3:
    s_bitcmp1_b32 s97, 4
    s_cbranch_scc0 L_t1poll_l4
    buffer_load_dword v28, v2, s[40:43], s95 offen offset:0 sc1
    buffer_load_dword v29, v2, s[40:43], s95 offen offset:1024 sc1
    buffer_load_dword v30, v2, s[40:43], s95 offen offset:2048 sc1
    buffer_load_dword v31, v2, s[40:43], s95 offen offset:3072 sc1
L_t1poll_l4:
    s_waitcnt vmcnt(0)
    s_bitcmp1_b32 s97, 0
    s_cbranch_scc0 L_t1poll_c0
    v_add_f32 v34, v32, v33
    v_cmp_u_f32 vcc, v34, v34
    s_nop 4
    s_cbranch_vccnz L_t1poll_c0
    s_bitset0_b32 s97, 0
    v_mov_b32 v34, v32
    s_nop 1
    v_max_f32_dpp v34, v34, v34 row_ror:8 row_mask:0xf bank_mask:0xf
    s_nop 1
    v_max_f32_dpp v34, v34, v34 row_ror:4 row_mask:0xf bank_mask:0xf
    s_nop 1
    v_max_f32_dpp v34, v34, v34 row_ror:2 row_mask:0xf bank_mask:0xf
    s_nop 1
    v_max_f32_dpp v34, v34, v34 row_ror:1 row_mask:0xf bank_mask:0xf
    v_sub_f32 v35, v32, v34
    v_exp_f32 v35, v35
    s_nop 0
    v_mul_f32 v36, v35, v33
    s_nop 1
    v_add_f32_dpp v36, v36, v36 row_ror:8 row_mask:0xf bank_mask:0xf
    s_nop 1
    v_add_f32_dpp v36, v36, v36 row_ror:4 row_mask:0xf bank_mask:0xf
    s_nop 1
    v_add_f32_dpp v36, v36, v36 row_ror:2 row_mask:0xf bank_mask:0xf
    s_nop 1
    v_add_f32_dpp v36, v36, v36 row_ror:1 row_mask:0xf bank_mask:0xf
    v_rcp_f32 v36, v36
    s_nop 0
    v_mul_f32 v35, v35, v36
    s_nop 1
L_t1poll_c0:
    s_bitcmp1_b32 s97, 1
    s_cbranch_scc0 L_t1poll_c1
    v_add_f32 v38, v16, v17
    v_add_f32 v39, v18, v19
    v_add_f32 v38, v38, v39
    v_cmp_u_f32 vcc, v38, v38
    s_nop 4
    s_cbranch_vccnz L_t1poll_c1
    s_bitset0_b32 s97, 1
L_t1poll_c1:
    s_bitcmp1_b32 s97, 2
    s_cbranch_scc0 L_t1poll_c2
    v_add_f32 v38, v20, v21
    v_add_f32 v39, v22, v23
    v_add_f32 v38, v38, v39
    v_cmp_u_f32 vcc, v38, v38
    s_nop 4
    s_cbranch_vccnz L_t1poll_c2
    s_bitset0_b32 s97, 2
L_t1poll_c2:
    s_bitcmp1_b32 s97, 3
    s_cbranch_scc0 L_t1poll_c3
    v_add_f32 v38, v24, v25
    v_add_f32 v39, v26, v27
    v_add_f32 v38, v38, v39
    v_cmp_u_f32 vcc, v38, v38
    s_nop 4
    s_cbranch_vccnz L_t1poll_c3
    s_bitset0_b32 s97, 3
L_t1poll_c3:
    s_bitcmp1_b32 s97, 4
    s_cbranch_scc0 L_t1poll_c4
    v_add_f32 v38, v28, v29
    v_add_f32 v39, v30, v31
    v_add_f32 v38, v38, v39
    v_cmp_u_f32 vcc, v38, v38
    s_nop 4
    s_cbranch_vccnz L_t1poll_c4
    s_bitset0_b32 s97, 4
L_t1poll_c4:
    s_cmp_eq_u32 s97, 0
    s_cbranch_scc1 L_t1poll_ok
    s_sub_u32 s83, s83, 1
    s_cmp_lg_u32 s83, 0
    s_cbranch_scc1 L_t1poll
L_t1poll_ok:
    v_mov_b32 v37, 0
    v_fmac_f32_dpp v37, v35, v16 row_newbcast:0 row_mask:0xf bank_mask:0xf
    v_fmac_f32_dpp v37, v35, v17 row_newbcast:1 row_mask:0xf bank_mask:0xf
    v_fmac_f32_dpp v37, v35, v18 row_newbcast:2 row_mask:0xf bank_mask:0xf
    v_fmac_f32_dpp v37, v35, v19 row_newbcast:3 row_mask:0xf bank_mask:0xf
    v_fmac_f32_dpp v37, v35, v20 row_newbcast:4 row_mask:0xf bank_mask:0xf
    v_fmac_f32_dpp v37, v35, v21 row_newbcast:5 row_mask:0xf bank_mask:0xf
    v_fmac_f32_dpp v37, v35, v22 row_newbcast:6 row_mask:0xf bank_mask:0xf
    v_fmac_f32_dpp v37, v35, v23 row_newbcast:7 row_mask:0xf bank_mask:0xf
    v_fmac_f32_dpp v37, v35, v24 row_newbcast:8 row_mask:0xf bank_mask:0xf
    v_fmac_f32_dpp v37, v35, v25 row_newbcast:9 row_mask:0xf bank_mask:0xf
    v_fmac_f32_dpp v37, v35, v26 row_newbcast:10 row_mask:0xf bank_mask:0xf
    v_fmac_f32_dpp v37, v35, v27 row_newbcast:11 row_mask:0xf bank_mask:0xf
    v_fmac_f32_dpp v37, v35, v28 row_newbcast:12 row_mask:0xf bank_mask:0xf
    v_fmac_f32_dpp v37, v35, v29 row_newbcast:13 row_mask:0xf bank_mask:0xf
    v_fmac_f32_dpp v37, v35, v30 row_newbcast:14 row_mask:0xf bank_mask:0xf
    v_fmac_f32_dpp v37, v35, v31 row_newbcast:15 row_mask:0xf bank_mask:0xf
    v_cvt_pk_bf16_f32 v37, v37, v37
    ds_write_b16 v8, v37 offset:512
    s_waitcnt lgkmcnt(0)
    s_barrier
    s_endpgm
L_wo_c:
    s_mov_b32 s60, s12
    s_and_b32 s61, s13, 0xffff
    s_mov_b32 s62, 4718592
    s_mov_b32 s63, 0x20000
    v_lshrrev_b32 v16, 3, v0
    v_and_b32 v17, 6, v16
    v_and_b32 v18, 7, v0
    v_xor_b32 v17, v17, v18
    v_mul_u32_u24 v16, 1152, v16
    v_lshl_add_u32 v16, v17, 4, v16
    s_mul_i32 s92, s87, 294912
    s_lshl_b32 s30, s90, 7
    s_add_u32 s92, s92, s30
    s_sub_u32 s30, s81, 4
    s_mul_i32 s30, s30, 11
    s_mul_i32 s93, s30, 9216
    s_add_u32 s92, s92, s93
    s_lshl_b32 s30, s30, 10
    s_add_u32 m0, s30, 16384
    s_nop 0
    buffer_load_dwordx4 v16, s[60:63], s92 offen nt lds
    s_add_u32 m0, m0, 1024
    s_add_u32 s92, s92, 9216
    buffer_load_dwordx4 v16, s[60:63], s92 offen nt lds
    s_add_u32 m0, m0, 1024
    s_add_u32 s92, s92, 9216
    buffer_load_dwordx4 v16, s[60:63], s92 offen nt lds
    s_add_u32 m0, m0, 1024
    s_add_u32 s92, s92, 9216
    buffer_load_dwordx4 v16, s[60:63], s92 offen nt lds
    s_add_u32 m0, m0, 1024
    s_add_u32 s92, s92, 9216
    buffer_load_dwordx4 v16, s[60:63], s92 offen nt lds
    s_add_u32 m0, m0, 1024
    s_add_u32 s92, s92, 9216
    buffer_load_dwordx4 v16, s[60:63], s92 offen nt lds
    s_add_u32 m0, m0, 1024
    s_add_u32 s92, s92, 9216
    buffer_load_dwordx4 v16, s[60:63], s92 offen nt lds
    s_add_u32 m0, m0, 1024
    s_add_u32 s92, s92, 9216
    buffer_load_dwordx4 v16, s[60:63], s92 offen nt lds
    s_add_u32 m0, m0, 1024
    s_add_u32 s92, s92, 9216
    buffer_load_dwordx4 v16, s[60:63], s92 offen nt lds
    s_add_u32 m0, m0, 1024
    s_add_u32 s92, s92, 9216
    buffer_load_dwordx4 v16, s[60:63], s92 offen nt lds
    s_add_u32 m0, m0, 1024
    s_add_u32 s92, s92, 9216
    s_cmp_eq_u32 s81, 6
    s_cbranch_scc1 L_wol_done
    buffer_load_dwordx4 v16, s[60:63], s92 offen nt lds
L_wol_done:
    s_waitcnt lgkmcnt(0)
    s_barrier
    s_barrier
    s_lshl_b32 s30, 1, s81
    v_mov_b32 v16, 0
    v_mov_b32 v17, s30
    s_waitcnt vmcnt(0)
    s_mov_b64 exec, 1
    ds_or_b32 v16, v17 offset:2608
    s_mov_b64 exec, -1
L_wo_mm:
    s_sub_u32 s30, s81, 4
    v_bfe_u32 v1, v0, 4, 1
    v_bfe_u32 v2, v0, 2, 2
    v_lshl_add_u32 v1, v1, 2, v2
    v_bfe_u32 v2, v0, 1, 1
    s_lshl_b32 s31, s30, 1
    v_add_u32 v2, s31, v2
    v_and_b32 v3, 6, v1
    v_xor_b32 v2, v2, v3
    v_lshlrev_b32 v2, 4, v2
    v_lshl_add_u32 v2, v1, 7, v2
    v_and_b32 v3, 1, v0
    v_lshl_add_u32 v2, v3, 3, v2
    v_lshrrev_b32 v3, 5, v0
    v_lshl_add_u32 v2, v3, 10, v2
    v_add_u32 v2, 16384, v2
    v_lshrrev_b32 v3, 4, v0
    v_lshlrev_b32 v3, 4, v3
    v_mov_b32 v8, 0
    s_mov_b32 s83, 200000
    s_nop 0
L_dfl:
    ds_read_b32 v9, v8 offset:2608
    s_waitcnt lgkmcnt(0)
    v_readfirstlane_b32 s31, v9
    s_cmp_eq_u32 s31, 112
    s_cbranch_scc1 L_dfl_ok
    s_sub_u32 s83, s83, 1
    s_cmp_lg_u32 s83, 0
    s_nop 0
    s_cbranch_scc1 L_dfl
L_dfl_ok:
    ds_read_b64_tr_b16 v[64:65], v2 offset:0
    ds_read_b64_tr_b16 v[66:67], v2 offset:2048
    ds_read_b64_tr_b16 v[68:69], v2 offset:4096
    ds_read_b64_tr_b16 v[70:71], v2 offset:6144
    ds_read_b64_tr_b16 v[72:73], v2 offset:8192
    ds_read_b64_tr_b16 v[74:75], v2 offset:10240
    ds_read_b64_tr_b16 v[76:77], v2 offset:12288
    ds_read_b64_tr_b16 v[78:79], v2 offset:14336
    ds_read_b64_tr_b16 v[80:81], v2 offset:16384
    ds_read_b64_tr_b16 v[82:83], v2 offset:18432
    ds_read_b64_tr_b16 v[84:85], v2 offset:20480
    ds_read_b64_tr_b16 v[86:87], v2 offset:22528
    ds_read_b64_tr_b16 v[88:89], v2 offset:24576
    ds_read_b64_tr_b16 v[90:91], v2 offset:26624
    ds_read_b64_tr_b16 v[92:93], v2 offset:28672
    ds_read_b64_tr_b16 v[94:95], v2 offset:30720
    s_mul_i32 s31, s87, 2304
    s_lshl_b32 s93, s90, 8
    s_add_u32 s93, s93, s31
    s_lshl_b32 s31, s30, 6
    s_add_u32 s93, s93, s31
    s_add_u32 s93, s93, 131072
    s_mov_b32 s30, 0x10001
    s_mov_b32 s31, 0x10001
    s_waitcnt lgkmcnt(0)
    s_barrier
    ds_read_b128 v[96:99], v3 offset:512
    ds_read_b128 v[100:103], v3 offset:576
    ds_read_b128 v[104:107], v3 offset:640
    ds_read_b128 v[108:111], v3 offset:704
    ds_read_b128 v[112:115], v3 offset:768
    ds_read_b128 v[116:119], v3 offset:832
    ds_read_b128 v[120:123], v3 offset:896
    ds_read_b128 v[124:127], v3 offset:960
    s_waitcnt lgkmcnt(7)
    v_mfma_f32_16x16x32_bf16 v[12:15], v[64:67], v[96:99], 0
    s_waitcnt lgkmcnt(6)
    v_mfma_f32_16x16x32_bf16 v[12:15], v[68:71], v[100:103], v[12:15]
    s_waitcnt lgkmcnt(5)
    v_mfma_f32_16x16x32_bf16 v[12:15], v[72:75], v[104:107], v[12:15]
    s_waitcnt lgkmcnt(4)
    v_mfma_f32_16x16x32_bf16 v[12:15], v[76:79], v[108:111], v[12:15]
    s_waitcnt lgkmcnt(3)
    v_mfma_f32_16x16x32_bf16 v[12:15], v[80:83], v[112:115], v[12:15]
    s_waitcnt lgkmcnt(2)
    v_mfma_f32_16x16x32_bf16 v[12:15], v[84:87], v[116:119], v[12:15]
    s_waitcnt lgkmcnt(1)
    v_mfma_f32_16x16x32_bf16 v[12:15], v[88:91], v[120:123], v[12:15]
    s_waitcnt lgkmcnt(0)
    v_mfma_f32_16x16x32_bf16 v[12:15], v[92:95], v[124:127], v[12:15]
    s_mov_b64 exec, s[30:31]
    s_nop 6
    buffer_store_dwordx4 v[12:15], v3, s[40:43], s93 offen sc1
    s_mov_b64 exec, -1
    s_nop 0
    s_branch L_fin
L_ffn_tail:
    v_mov_b32 v15, 1
    s_mov_b64 exec, 1
    ds_add_u32 v14, v15 offset:2596
    s_mov_b64 exec, -1
    v_bfe_u32 v1, v0, 3, 1
    v_lshrrev_b32 v2, 4, v0
    v_lshl_add_u32 v1, v1, 2, v2
    v_mul_u32_u24 v8, 80, v1
    s_and_b32 s30, s81, 3
    s_mul_i32 s30, s30, 640
    s_add_u32 s30, s30, 16384
    v_add_u32 v8, s30, v8
    v_lshlrev_b32 v11, 2, v1
    v_lshrrev_b32 v12, 4, v0
    v_lshlrev_b32 v12, 3, v12
    v_and_b32 v9, 7, v0
    v_lshl_add_u32 v12, v9, 5, v12
    s_lshl_b32 s30, s81, 8
    s_add_u32 s30, s30, 24576
    v_add_u32 v9, s30, v12
    v_lshlrev_b32 v10, 2, v0
    v_add_u32 v10, 24576, v10
    v_and_b32 v14, 3, v0
    v_mov_b32 v6, 0xffff
    v_mov_b32 v7, 0xffff0000
    v_cmp_eq_u32 vcc, 0, v14
    s_nop 1
    v_cndmask_b32 v4, 0, v6, vcc
    v_cmp_eq_u32 vcc, 1, v14
    s_nop 1
    v_cndmask_b32 v4, v4, v7, vcc
    v_cmp_eq_u32 vcc, 2, v14
    s_nop 1
    v_cndmask_b32 v5, 0, v6, vcc
    v_cmp_eq_u32 vcc, 3, v14
    s_nop 1
    v_cndmask_b32 v5, v5, v7, vcc
    s_cmp_lt_u32 s81, 3
    s_cbranch_scc0 L_ffn_nog
    s_lshl_b32 s30, s81, 6
    v_add_u32 v52, s30, v0
    v_lshlrev_b32 v53, 4, v52
    v_lshlrev_b32 v54, 3, v52
    v_cmp_gt_u32 vcc, 144, v52
    v_mov_b32 v55, 0x7ffffff0
    s_nop 0
    v_cndmask_b32 v55, v55, v53, vcc
    v_min_u32 v56, 143, v52
    v_lshlrev_b32 v56, 4, v56
    v_mul_u32_u24 v57, 57, v52
    v_lshrrev_b32 v57, 11, v57
    v_mul_u32_u24 v58, 36, v57
    v_sub_u32 v58, v52, v58
    v_mul_u32_u24 v57, 640, v57
    v_lshrrev_b32 v59, 1, v58
    v_lshl_add_u32 v57, v59, 2, v57
    v_and_b32 v58, 1, v58
    v_mul_u32_u24 v58, 320, v58
    v_add_u32 v57, v57, v58
    v_add_u32 v57, 16384, v57
    buffer_load_dwordx2 v[92:93], v54, s[44:47], 0 offen
    s_mov_b32 s92, 114688
    s_mov_b32 s93, 116992
    s_mov_b32 s94, 119296
    buffer_load_dwordx4 v[124:127], v56, s[40:43], s92 offen sc1
    buffer_load_dwordx4 v[188:191], v56, s[40:43], s93 offen sc1
    buffer_load_dwordx4 v[156:159], v56, s[40:43], s94 offen sc1
L_ffn_nog:
    buffer_load_dwordx4 v[64:67], v60, s[64:67], s52 offen nt
    s_add_u32 s92, s52, 73728
    buffer_load_dwordx4 v[68:71], v60, s[64:67], s92 offen nt
    s_add_u32 s92, s52, 147456
    buffer_load_dwordx4 v[72:75], v60, s[64:67], s92 offen nt
    s_add_u32 s92, s52, 221184
    buffer_load_dwordx4 v[76:79], v60, s[64:67], s92 offen nt
    s_add_u32 s92, s52, 294912
    buffer_load_dwordx4 v[96:99], v60, s[64:67], s92 offen nt
    s_add_u32 s92, s52, 368640
    buffer_load_dwordx4 v[100:103], v60, s[64:67], s92 offen nt
    s_add_u32 s92, s52, 442368
    buffer_load_dwordx4 v[104:107], v60, s[64:67], s92 offen nt
    s_add_u32 s92, s52, 516096
    buffer_load_dwordx4 v[108:111], v60, s[64:67], s92 offen nt
    s_add_u32 s92, s52, 589824
    buffer_load_dwordx4 v[128:131], v60, s[64:67], s92 offen nt
    s_add_u32 s92, s52, 663552
    buffer_load_dwordx4 v[132:135], v60, s[64:67], s92 offen nt
    s_barrier
    s_add_u32 s92, s52, 737280
    buffer_load_dwordx4 v[136:139], v60, s[64:67], s92 offen nt
    s_add_u32 s92, s52, 811008
    buffer_load_dwordx4 v[140:143], v60, s[64:67], s92 offen nt
    s_add_u32 s92, s52, 884736
    buffer_load_dwordx4 v[160:163], v60, s[64:67], s92 offen nt
    s_add_u32 s92, s52, 958464
    buffer_load_dwordx4 v[164:167], v60, s[64:67], s92 offen nt
    s_add_u32 s92, s52, 1032192
    buffer_load_dwordx4 v[168:171], v60, s[64:67], s92 offen nt
    s_add_u32 s92, s52, 1105920
    buffer_load_dwordx4 v[172:175], v60, s[64:67], s92 offen nt
    s_add_u32 s92, s52, 1179648
    buffer_load_dwordx4 v[192:195], v60, s[64:67], s92 offen nt
    s_add_u32 s92, s52, 1253376
    buffer_load_dwordx4 v[196:199], v60, s[64:67], s92 offen nt
    buffer_load_dwordx4 v[200:203], v61, s[72:75], s53 offen nt
    s_add_u32 s92, s53, 9216
    buffer_load_dwordx4 v[204:207], v61, s[72:75], s92 offen nt
L_ffn_post:
    s_cmp_lt_u32 s81, 3
    s_cbranch_scc0 L_ffn_w3
    s_mov_b32 s92, 114688
    s_mov_b32 s93, 116992
    s_mov_b32 s94, 119296
    s_waitcnt vmcnt(20)
    v_max_u32 v58, v125, v127
    v_min_u32 v59, v125, v127
    v_max3_u32 v58, v58, v189, v191
    v_min3_u32 v59, v59, v189, v191
    v_max3_u32 v58, v58, v157, v159
    v_min3_u32 v59, v59, v157, v159
    v_xor_b32 v58, s80, v58
    v_xor_b32 v59, s80, v59
    v_or_b32 v58, v58, v59
    v_cmp_ne_u32 vcc, 0, v58
    s_nop 4
    s_cbranch_vccz L_p3poll_ok
    s_mov_b32 s83, 50000
L_p3poll:
    buffer_load_dwordx4 v[124:127], v56, s[40:43], s92 offen sc1
    buffer_load_dwordx4 v[188:191], v56, s[40:43], s93 offen sc1
    buffer_load_dwordx4 v[156:159], v56, s[40:43], s94 offen sc1
    s_waitcnt vmcnt(0)
    v_max_u32 v58, v125, v127
    v_min_u32 v59, v125, v127
    v_max3_u32 v58, v58, v189, v191
    v_min3_u32 v59, v59, v189, v191
    v_max3_u32 v58, v58, v157, v159
    v_min3_u32 v59, v59, v157, v159
    v_xor_b32 v58, s80, v58
    v_xor_b32 v59, s80, v59
    v_or_b32 v58, v58, v59
    v_cmp_ne_u32 vcc, 0, v58
    s_cbranch_vccz L_p3poll_ok
    s_sub_u32 s83, s83, 1
    s_cmp_lg_u32 s83, 0
    s_nop 1
    s_cbranch_scc1 L_p3poll
L_p3poll_ok:
    v_lshlrev_b32 v152, 16, v92
    v_and_b32 v153, 0xffff0000, v92
    v_lshlrev_b32 v154, 16, v93
    v_and_b32 v155, 0xffff0000, v93
    v_lshlrev_b32 v184, 16, v124
    v_and_b32 v185, 0xffff0000, v124
    v_lshlrev_b32 v186, 16, v126
    v_and_b32 v187, 0xffff0000, v126
    v_lshlrev_b32 v216, 16, v156
    v_and_b32 v217, 0xffff0000, v156
    v_lshlrev_b32 v218, 16, v158
    v_and_b32 v219, 0xffff0000, v158
    v_lshlrev_b32 v244, 16, v188
    v_and_b32 v245, 0xffff0000, v188
    v_lshlrev_b32 v246, 16, v190
    v_and_b32 v247, 0xffff0000, v190
    v_add_f32 v216, 1.0, v216
    v_add_f32 v217, 1.0, v217
    v_add_f32 v218, 1.0, v218
    v_add_f32 v219, 1.0, v219
    v_cvt_pk_bf16_f32 v216, 0, v216
    v_cvt_pk_bf16_f32 v217, 0, v217
    v_cvt_pk_bf16_f32 v218, 0, v218
    v_cvt_pk_bf16_f32 v219, 0, v219
    s_mov_b32 s92, 131072
    s_mov_b32 s93, 135680
    s_mov_b32 s94, 140288
    s_mov_b32 s95, 144896
    s_mov_b32 s96, 149504
    s_mov_b32 s97, 154112
    s_mov_b32 s98, 158720
    s_mov_b32 s99, 163328
    v_mov_b32 v58, 0
    s_mov_b32 s83, 200000
    s_nop 0
L_hfl:
    ds_read_b32 v59, v58 offset:2600
    s_waitcnt lgkmcnt(0)
    v_readfirstlane_b32 s30, v59
    s_cmp_eq_u32 s30, 1
    s_cbranch_scc1 L_hfl_ok
    s_sub_u32 s83, s83, 1
    s_cmp_lg_u32 s83, 0
    s_nop 0
    s_cbranch_scc1 L_hfl
L_hfl_ok:
    v_mul_u32_u24 v58, 2304, v0
    s_lshl_b32 s30, s81, 10
    s_add_u32 s30, s30, 131072
    s_mov_b64 exec, 0xffff
    s_mov_b32 s83, 50000
L_t2gate:
    buffer_load_dword v59, v58, s[40:43], s30 offen sc1
    s_waitcnt vmcnt(0)
    v_cmp_o_f32 vcc, v59, v59
    s_cbranch_vccnz L_t2gate_ok
    s_sub_u32 s83, s83, 1
    s_cmp_lg_u32 s83, 0
    s_nop 1
    s_cbranch_scc1 L_t2gate
L_t2gate_ok:
    s_mov_b64 exec, -1
    s_mov_b32 s31, 15
    s_mov_b32 s83, 50000
L_t2poll:
    s_bitcmp1_b32 s31, 0
    s_cbranch_scc0 L_t2poll_l0
    buffer_load_dwordx4 v[16:19], v55, s[40:43], s92 offen offset:0 sc1
    buffer_load_dwordx4 v[20:23], v55, s[40:43], s92 offen offset:2304 sc1
    buffer_load_dwordx4 v[24:27], v55, s[40:43], s93 offen offset:0 sc1
    buffer_load_dwordx4 v[28:31], v55, s[40:43], s93 offen offset:2304 sc1
L_t2poll_l0:
    s_bitcmp1_b32 s31, 1
    s_cbranch_scc0 L_t2poll_l1
    buffer_load_dwordx4 v[32:35], v55, s[40:43], s94 offen offset:0 sc1
    buffer_load_dwordx4 v[36:39], v55, s[40:43], s94 offen offset:2304 sc1
    buffer_load_dwordx4 v[40:43], v55, s[40:43], s95 offen offset:0 sc1
    buffer_load_dwordx4 v[44:47], v55, s[40:43], s95 offen offset:2304 sc1
L_t2poll_l1:
    s_bitcmp1_b32 s31, 2
    s_cbranch_scc0 L_t2poll_l2
    buffer_load_dwordx4 v[48:51], v55, s[40:43], s96 offen offset:0 sc1
    buffer_load_dwordx4 v[224:227], v55, s[40:43], s96 offen offset:2304 sc1
    buffer_load_dwordx4 v[116:119], v55, s[40:43], s97 offen offset:0 sc1
    buffer_load_dwordx4 v[148:151], v55, s[40:43], s97 offen offset:2304 sc1
L_t2poll_l2:
    s_bitcmp1_b32 s31, 3
    s_cbranch_scc0 L_t2poll_l3
    buffer_load_dwordx4 v[180:183], v55, s[40:43], s98 offen offset:0 sc1
    buffer_load_dwordx4 v[212:215], v55, s[40:43], s98 offen offset:2304 sc1
    buffer_load_dwordx4 v[88:91], v55, s[40:43], s99 offen offset:0 sc1
    buffer_load_dwordx4 v[120:123], v55, s[40:43], s99 offen offset:2304 sc1
L_t2poll_l3:
    s_waitcnt vmcnt(0)
    s_bitcmp1_b32 s31, 0
    s_cbranch_scc0 L_t2poll_c0
    v_pk_add_f32 v[16:17], v[16:17], v[20:21]
    v_pk_add_f32 v[24:25], v[24:25], v[28:29]
    v_pk_add_f32 v[18:19], v[18:19], v[22:23]
    v_pk_add_f32 v[26:27], v[26:27], v[30:31]
    v_pk_add_f32 v[16:17], v[16:17], v[24:25]
    v_pk_add_f32 v[18:19], v[18:19], v[26:27]
    v_add_f32 v248, v16, v17
    v_add_f32 v249, v18, v19
    v_add_f32 v248, v248, v249
    v_cmp_u_f32 vcc, v248, v248
    s_nop 4
    s_cbranch_vccnz L_t2poll_c0
    s_bitset0_b32 s31, 0
L_t2poll_c0:
    s_bitcmp1_b32 s31, 1
    s_cbranch_scc0 L_t2poll_c1
    v_pk_add_f32 v[32:33], v[32:33], v[36:37]
    v_pk_add_f32 v[40:41], v[40:41], v[44:45]
    v_pk_add_f32 v[34:35], v[34:35], v[38:39]
    v_pk_add_f32 v[42:43], v[42:43], v[46:47]
    v_pk_add_f32 v[32:33], v[32:33], v[40:41]
    v_pk_add_f32 v[34:35], v[34:35], v[42:43]
    v_add_f32 v248, v32, v33
    v_add_f32 v249, v34, v35
    v_add_f32 v248, v248, v249
    v_cmp_u_f32 vcc, v248, v248
    s_nop 4
    s_cbranch_vccnz L_t2poll_c1
    s_bitset0_b32 s31, 1
L_t2poll_c1:
    s_bitcmp1_b32 s31, 2
    s_cbranch_scc0 L_t2poll_c2
    v_pk_add_f32 v[48:49], v[48:49], v[224:225]
    v_pk_add_f32 v[116:117], v[116:117], v[148:149]
    v_pk_add_f32 v[50:51], v[50:51], v[226:227]
    v_pk_add_f32 v[118:119], v[118:119], v[150:151]
    v_pk_add_f32 v[48:49], v[48:49], v[116:117]
    v_pk_add_f32 v[50:51], v[50:51], v[118:119]
    v_add_f32 v248, v48, v49
    v_add_f32 v249, v50, v51
    v_add_f32 v248, v248, v249
    v_cmp_u_f32 vcc, v248, v248
    s_nop 4
    s_cbranch_vccnz L_t2poll_c2
    s_bitset0_b32 s31, 2
L_t2poll_c2:
    s_bitcmp1_b32 s31, 3
    s_cbranch_scc0 L_t2poll_c3
    v_pk_add_f32 v[180:181], v[180:181], v[212:213]
    v_pk_add_f32 v[88:89], v[88:89], v[120:121]
    v_pk_add_f32 v[182:183], v[182:183], v[214:215]
    v_pk_add_f32 v[90:91], v[90:91], v[122:123]
    v_pk_add_f32 v[180:181], v[180:181], v[88:89]
    v_pk_add_f32 v[182:183], v[182:183], v[90:91]
    v_add_f32 v248, v180, v181
    v_add_f32 v249, v182, v183
    v_add_f32 v248, v248, v249
    v_cmp_u_f32 vcc, v248, v248
    s_nop 4
    s_cbranch_vccnz L_t2poll_c3
    s_bitset0_b32 s31, 3
L_t2poll_c3:
    s_cmp_eq_u32 s31, 0
    s_cbranch_scc1 L_t2poll_ok
    s_sub_u32 s83, s83, 1
    s_cmp_lg_u32 s83, 0
    s_cbranch_scc1 L_t2poll
L_t2poll_ok:
    v_pk_add_f32 v[16:17], v[16:17], v[32:33]
    v_pk_add_f32 v[48:49], v[48:49], v[180:181]
    v_pk_add_f32 v[18:19], v[18:19], v[34:35]
    v_pk_add_f32 v[50:51], v[50:51], v[182:183]
    v_pk_add_f32 v[220:221], v[16:17], v[48:49]
    v_pk_add_f32 v[222:223], v[18:19], v[50:51]
    v_cvt_pk_bf16_f32 v220, 0, v220
    v_cvt_pk_bf16_f32 v221, 0, v221
    v_cvt_pk_bf16_f32 v222, 0, v222
    v_cvt_pk_bf16_f32 v223, 0, v223
    v_pk_mul_f32 v[220:221], v[220:221], v[184:185]
    v_pk_mul_f32 v[222:223], v[222:223], v[186:187]
    v_cvt_pk_bf16_f32 v220, 0, v220
    v_cvt_pk_bf16_f32 v221, 0, v221
    v_cvt_pk_bf16_f32 v222, 0, v222
    v_cvt_pk_bf16_f32 v223, 0, v223
    v_pk_add_f32 v[220:221], v[220:221], v[152:153]
    v_pk_add_f32 v[222:223], v[222:223], v[154:155]
    v_cvt_pk_bf16_f32 v220, 0, v220
    v_cvt_pk_bf16_f32 v221, 0, v221
    v_cvt_pk_bf16_f32 v222, 0, v222
    v_cvt_pk_bf16_f32 v223, 0, v223
    ds_write_b128 v53, v[220:223] offset:5888
    v_add_f32 v248, v220, v221
    v_mul_f32 v249, v220, v220
    v_add_f32 v250, v222, v223
    v_fmac_f32 v249, v221, v221
    v_add_f32 v248, v248, v250
    v_fmac_f32 v249, v222, v222
    v_fmac_f32 v249, v223, v223
    v_add_f32_dpp v248, v248, v248 row_ror:8 row_mask:0xf bank_mask:0xf
    s_nop 0
    v_add_f32_dpp v249, v249, v249 row_ror:8 row_mask:0xf bank_mask:0xf
    v_add_f32_dpp v248, v248, v248 row_ror:4 row_mask:0xf bank_mask:0xf
    s_nop 0
    v_add_f32_dpp v249, v249, v249 row_ror:4 row_mask:0xf bank_mask:0xf
    v_add_f32_dpp v248, v248, v248 row_ror:2 row_mask:0xf bank_mask:0xf
    s_nop 0
    v_add_f32_dpp v249, v249, v249 row_ror:2 row_mask:0xf bank_mask:0xf
    v_add_f32_dpp v248, v248, v248 row_ror:1 row_mask:0xf bank_mask:0xf
    s_nop 0
    v_add_f32_dpp v249, v249, v249 row_ror:1 row_mask:0xf bank_mask:0xf
    v_mov_b32 v250, v248
    v_mov_b32 v251, v249
    s_nop 0
    v_permlane16_swap_b32 v248, v250
    v_permlane16_swap_b32 v249, v251
    v_add_f32 v248, v248, v250
    v_add_f32 v249, v249, v251
    v_mov_b32 v250, v248
    v_mov_b32 v251, v249
    s_nop 0
    v_permlane32_swap_b32 v248, v250
    v_permlane32_swap_b32 v249, v251
    v_add_f32 v248, v248, v250
    v_add_f32 v249, v249, v251
    s_lshl_b32 s30, s81, 3
    v_mov_b32 v250, s30
    s_mov_b64 exec, 1
    ds_write_b64 v250, v[248:249] offset:2560
    s_mov_b64 exec, -1
    s_waitcnt lgkmcnt(0)
    s_barrier
    v_mov_b32 v250, 0
    ds_read_b128 v[20:23], v250 offset:2560
    ds_read_b64 v[24:25], v250 offset:2576
    s_waitcnt lgkmcnt(0)
    v_add_f32 v248, v20, v22
    v_add_f32 v249, v21, v23
    v_add_f32 v248, v248, v24
    v_add_f32 v249, v249, v25
    v_mul_f32 v248, 0x3ae38e39, v248
    v_mul_f32 v249, 0x3ae38e39, v249
    v_fma_f32 v249, -v248, v248, v249
    v_max_f32 v249, 0, v249
    v_cvt_pk_bf16_f32 v248, 0, v248
    v_cvt_pk_bf16_f32 v249, 0, v249
    v_add_f32 v249, 0x3727c5ac, v249
    v_cvt_pk_bf16_f32 v249, 0, v249
    v_sqrt_f32 v249, v249
    s_nop 0
    v_cvt_pk_bf16_f32 v249, 0, v249
    v_rcp_f32 v249, v249
    v_sub_f32 v220, v220, v248
    v_sub_f32 v221, v221, v248
    v_sub_f32 v222, v222, v248
    v_sub_f32 v223, v223, v248
    v_cvt_pk_bf16_f32 v220, 0, v220
    v_cvt_pk_bf16_f32 v221, 0, v221
    v_cvt_pk_bf16_f32 v222, 0, v222
    v_cvt_pk_bf16_f32 v223, 0, v223
    v_mul_f32 v220, v220, v249
    v_mul_f32 v221, v221, v249
    v_mul_f32 v222, v222, v249
    v_mul_f32 v223, v223, v249
    v_cvt_pk_bf16_f32 v220, 0, v220
    v_cvt_pk_bf16_f32 v221, 0, v221
    v_cvt_pk_bf16_f32 v222, 0, v222
    v_cvt_pk_bf16_f32 v223, 0, v223
    v_pk_mul_f32 v[220:221], v[220:221], v[216:217]
    v_pk_mul_f32 v[222:223], v[222:223], v[218:219]
    v_cvt_pk_bf16_f32 v220, 0, v220
    v_cvt_pk_bf16_f32 v221, 0, v221
    v_cvt_pk_bf16_f32 v222, 0, v222
    v_cvt_pk_bf16_f32 v223, 0, v223
    v_pk_add_f32 v[220:221], v[220:221], v[244:245]
    v_pk_add_f32 v[222:223], v[222:223], v[246:247]
    v_cvt_pk_bf16_f32 v220, v220, v220
    v_cvt_pk_bf16_f32 v221, v221, v221
    v_cvt_pk_bf16_f32 v222, v222, v222
    v_cvt_pk_bf16_f32 v223, v223, v223
    ds_write2_b32 v57, v220, v221 offset0:0 offset1:20
    ds_write2_b32 v57, v222, v223 offset0:40 offset1:60
    s_waitcnt lgkmcnt(0)
    s_branch L_ffn_b4
L_ffn_w3:
    s_cmp_eq_u32 s81, 6
    s_cbranch_scc0 L_ffn_nogb
    v_and_b32 v56, 3, v0
    v_lshlrev_b32 v56, 4, v56
    s_min_u32 s92, s90, 35
    s_lshl_b32 s92, s92, 6
    s_add_u32 s92, s92, 121600
    s_mov_b32 s83, 50000
L_gbpoll:
    buffer_load_dwordx4 v[252:255], v56, s[40:43], s92 offen sc1
    s_waitcnt vmcnt(0)
    v_max_u32 v58, v253, v255
    v_min_u32 v59, v253, v255
    v_xor_b32 v58, s80, v58
    v_xor_b32 v59, s80, v59
    v_or_b32 v58, v58, v59
    v_cmp_ne_u32 vcc, 0, v58
    s_cbranch_vccz L_gbpoll_ok
    s_sub_u32 s83, s83, 1
    s_cmp_lg_u32 s83, 0
    s_nop 1
    s_cbranch_scc1 L_gbpoll
L_gbpoll_ok:
L_ffn_nogb:
    s_barrier
    s_cmp_eq_u32 s81, 7
    s_cbranch_scc1 L_ffn_b4
    s_add_u32 s92, s53, 18432
    buffer_load_dwordx4 v[80:83], v61, s[72:75], s92 offen nt
    s_add_u32 s92, s53, 27648
    buffer_load_dwordx4 v[112:115], v61, s[72:75], s92 offen nt
    s_add_u32 s92, s53, 36864
    buffer_load_dwordx4 v[144:147], v61, s[72:75], s92 offen nt
    s_add_u32 s92, s53, 46080
    buffer_load_dwordx4 v[176:179], v61, s[72:75], s92 offen nt
    s_add_u32 s92, s53, 55296
    buffer_load_dwordx4 v[208:211], v61, s[72:75], s92 offen nt
    s_add_u32 s92, s53, 64512
    buffer_load_dwordx4 v[84:87], v61, s[72:75], s92 offen nt
L_ffn_b4:
    s_barrier
    ds_read_b128 v[16:19], v8 offset:0
    ds_read_b128 v[20:23], v8 offset:16
    ds_read_b128 v[24:27], v8 offset:32
    ds_read_b128 v[28:31], v8 offset:48
    ds_read_b128 v[32:35], v8 offset:64
    s_cmp_lt_u32 s81, 3
    s_cbranch_scc0 L_ffn_nwl
    s_add_u32 s92, s53, 18432
    buffer_load_dwordx4 v[80:83], v61, s[72:75], s92 offen nt
    s_add_u32 s92, s53, 27648
    buffer_load_dwordx4 v[112:115], v61, s[72:75], s92 offen nt
    s_add_u32 s92, s53, 36864
    buffer_load_dwordx4 v[144:147], v61, s[72:75], s92 offen nt
    s_add_u32 s92, s53, 46080
    buffer_load_dwordx4 v[176:179], v61, s[72:75], s92 offen nt
    s_add_u32 s92, s53, 55296
    buffer_load_dwordx4 v[208:211], v61, s[72:75], s92 offen nt
    s_add_u32 s92, s53, 64512
    buffer_load_dwordx4 v[84:87], v61, s[72:75], s92 offen nt
L_ffn_nwl:
    s_mov_b32 s92, 0x3d372713
    s_mov_b32 s30, 0x00ff00ff
    s_mov_b32 s31, 0x00ff00ff
    s_mul_i32 s93, s90, 2304
    s_lshl_b32 s94, s81, 8
    s_add_u32 s93, s93, s94
    s_add_u32 s93, s93, 589824
    s_waitcnt vmcnt(6) lgkmcnt(0)
    v_and_b32 v40, v16, v4
    v_and_b32 v41, v16, v5
    v_and_b32 v42, v17, v4
    v_and_b32 v43, v17, v5
    v_mfma_f32_4x4x4_16b_bf16 v[48:51], v[40:41], v[64:65], 0
    v_mfma_f32_4x4x4_16b_bf16 v[52:55], v[40:41], v[66:67], 0
    v_and_b32 v40, v18, v4
    v_and_b32 v41, v18, v5
    v_mfma_f32_4x4x4_16b_bf16 v[48:51], v[42:43], v[68:69], v[48:51]
    v_mfma_f32_4x4x4_16b_bf16 v[52:55], v[42:43], v[70:71], v[52:55]
    v_and_b32 v42, v19, v4
    v_and_b32 v43, v19, v5
    v_mfma_f32_4x4x4_16b_bf16 v[48:51], v[40:41], v[72:73], v[48:51]
    v_mfma_f32_4x4x4_16b_bf16 v[52:55], v[40:41], v[74:75], v[52:55]
    v_and_b32 v40, v20, v4
    v_and_b32 v41, v20, v5
    v_mfma_f32_4x4x4_16b_bf16 v[48:51], v[42:43], v[76:77], v[48:51]
    v_mfma_f32_4x4x4_16b_bf16 v[52:55], v[42:43], v[78:79], v[52:55]
    v_and_b32 v42, v21, v4
    v_and_b32 v43, v21, v5
    v_mfma_f32_4x4x4_16b_bf16 v[48:51], v[40:41], v[96:97], v[48:51]
    v_mfma_f32_4x4x4_16b_bf16 v[52:55], v[40:41], v[98:99], v[52:55]
    v_and_b32 v40, v22, v4
    v_and_b32 v41, v22, v5
    v_mfma_f32_4x4x4_16b_bf16 v[48:51], v[42:43], v[100:101], v[48:51]
    v_mfma_f32_4x4x4_16b_bf16 v[52:55], v[42:43], v[102:103], v[52:55]
    v_and_b32 v42, v23, v4
    v_and_b32 v43, v23, v5
    v_mfma_f32_4x4x4_16b_bf16 v[48:51], v[40:41], v[104:105], v[48:51]
    v_mfma_f32_4x4x4_16b_bf16 v[52:55], v[40:41], v[106:107], v[52:55]
    v_and_b32 v40, v24, v4
    v_and_b32 v41, v24, v5
    v_mfma_f32_4x4x4_16b_bf16 v[48:51], v[42:43], v[108:109], v[48:51]
    v_mfma_f32_4x4x4_16b_bf16 v[52:55], v[42:43], v[110:111], v[52:55]
    v_and_b32 v42, v25, v4
    v_and_b32 v43, v25, v5
    v_mfma_f32_4x4x4_16b_bf16 v[48:51], v[40:41], v[128:129], v[48:51]
    v_mfma_f32_4x4x4_16b_bf16 v[52:55], v[40:41], v[130:131], v[52:55]
    v_and_b32 v40, v26, v4
    v_and_b32 v41, v26, v5
    v_mfma_f32_4x4x4_16b_bf16 v[48:51], v[42:43], v[132:133], v[48:51]
    v_mfma_f32_4x4x4_16b_bf16 v[52:55], v[42:43], v[134:135], v[52:55]
    v_and_b32 v42, v27, v4
    v_and_b32 v43, v27, v5
    v_mfma_f32_4x4x4_16b_bf16 v[48:51], v[40:41], v[136:137], v[48:51]
    v_mfma_f32_4x4x4_16b_bf16 v[52:55], v[40:41], v[138:139], v[52:55]
    v_and_b32 v40, v28, v4
    v_and_b32 v41, v28, v5
    v_mfma_f32_4x4x4_16b_bf16 v[48:51], v[42:43], v[140:141], v[48:51]
    v_mfma_f32_4x4x4_16b_bf16 v[52:55], v[42:43], v[142:143], v[52:55]
    v_and_b32 v42, v29, v4
    v_and_b32 v43, v29, v5
    v_mfma_f32_4x4x4_16b_bf16 v[48:51], v[40:41], v[160:161], v[48:51]
    v_mfma_f32_4x4x4_16b_bf16 v[52:55], v[40:41], v[162:163], v[52:55]
    v_and_b32 v40, v30, v4
    v_and_b32 v41, v30, v5
    v_mfma_f32_4x4x4_16b_bf16 v[48:51], v[42:43], v[164:165], v[48:51]
    v_mfma_f32_4x4x4_16b_bf16 v[52:55], v[42:43], v[166:167], v[52:55]
    v_and_b32 v42, v31, v4
    v_and_b32 v43, v31, v5
    v_mfma_f32_4x4x4_16b_bf16 v[48:51], v[40:41], v[168:169], v[48:51]
    v_mfma_f32_4x4x4_16b_bf16 v[52:55], v[40:41], v[170:171], v[52:55]
    v_and_b32 v40, v32, v4
    v_and_b32 v41, v32, v5
    v_mfma_f32_4x4x4_16b_bf16 v[48:51], v[42:43], v[172:173], v[48:51]
    v_mfma_f32_4x4x4_16b_bf16 v[52:55], v[42:43], v[174:175], v[52:55]
    v_and_b32 v42, v33, v4
    v_and_b32 v43, v33, v5
    v_mfma_f32_4x4x4_16b_bf16 v[48:51], v[40:41], v[192:193], v[48:51]
    v_mfma_f32_4x4x4_16b_bf16 v[52:55], v[40:41], v[194:195], v[52:55]
    s_nop 0
    v_mfma_f32_4x4x4_16b_bf16 v[48:51], v[42:43], v[196:197], v[48:51]
    v_mfma_f32_4x4x4_16b_bf16 v[52:55], v[42:43], v[198:199], v[52:55]
    s_nop 4
    v_permlane32_swap_b32 v48, v52
    v_permlane32_swap_b32 v49, v53
    v_permlane32_swap_b32 v50, v54
    v_permlane32_swap_b32 v51, v55
    v_add_f32 v48, v48, v52
    v_add_f32 v49, v49, v53
    v_add_f32 v50, v50, v54
    v_add_f32 v51, v51, v55
    s_nop 0
    v_permlane16_swap_b32 v48, v50
    v_permlane16_swap_b32 v49, v51
    v_add_f32 v48, v48, v50
    v_add_f32 v49, v49, v51
    s_nop 0
    v_add_f32_dpp v48, v48, v48 row_ror:8 row_mask:0xf bank_mask:0xf
    v_add_f32_dpp v49, v49, v49 row_ror:8 row_mask:0xf bank_mask:0xf
    s_mov_b64 exec, s[30:31]
    ds_write_b64 v9, v[48:49]
    s_mov_b64 exec, -1
    s_waitcnt lgkmcnt(0)
    s_barrier
    ds_read_b32 v16, v10 offset:0
    ds_read_b32 v17, v10 offset:256
    ds_read_b32 v18, v10 offset:512
    ds_read_b32 v19, v10 offset:768
    ds_read_b32 v20, v10 offset:1024
    ds_read_b32 v21, v10 offset:1280
    ds_read_b32 v22, v10 offset:1536
    ds_read_b32 v23, v10 offset:1792
    s_waitcnt lgkmcnt(4)
    v_add_f32 v16, v16, v17
    v_add_f32 v18, v18, v19
    v_add_f32 v24, v16, v18
    s_waitcnt lgkmcnt(0)
    v_add_f32 v20, v20, v21
    v_add_f32 v22, v22, v23
    v_add_f32 v25, v20, v22
    v_cvt_pk_bf16_f32 v24, 0, v24
    v_cvt_pk_bf16_f32 v25, 0, v25
    v_mul_f32 v26, v24, v24
    v_fma_f32 v26, v26, s92, 1.0
    v_mul_f32 v26, v26, v24
    v_mul_f32 v26, 0xc0135761, v26
    v_exp_f32 v26, v26
    s_nop 0
    v_add_f32 v26, 1.0, v26
    v_rcp_f32 v26, v26
    s_nop 0
    v_mul_f32 v26, v26, v24
    v_cvt_pk_bf16_f32 v26, 0, v26
    v_mul_f32 v26, v26, v25
    v_cvt_pk_bf16_f32 v26, v26, v26
    ds_bpermute_b32 v16, v11, v26 offset:0
    ds_bpermute_b32 v17, v11, v26 offset:32
    ds_bpermute_b32 v18, v11, v26 offset:64
    ds_bpermute_b32 v19, v11, v26 offset:96
    ds_bpermute_b32 v20, v11, v26 offset:128
    ds_bpermute_b32 v21, v11, v26 offset:160
    ds_bpermute_b32 v22, v11, v26 offset:192
    ds_bpermute_b32 v23, v11, v26 offset:224
    s_waitcnt lgkmcnt(0)
    s_cmp_eq_u32 s81, 7
    s_cbranch_scc1 L_ffn_d7
    v_and_b32 v40, v16, v4
    v_and_b32 v41, v16, v5
    v_and_b32 v42, v17, v4
    v_and_b32 v43, v17, v5
    v_mfma_f32_4x4x4_16b_bf16 v[48:51], v[40:41], v[200:201], 0
    v_mfma_f32_4x4x4_16b_bf16 v[52:55], v[40:41], v[202:203], 0
    v_and_b32 v40, v18, v4
    v_and_b32 v41, v18, v5
    v_mfma_f32_4x4x4_16b_bf16 v[48:51], v[42:43], v[204:205], v[48:51]
    v_mfma_f32_4x4x4_16b_bf16 v[52:55], v[42:43], v[206:207], v[52:55]
    v_and_b32 v42, v19, v4
    v_and_b32 v43, v19, v5
    s_waitcnt vmcnt(5)
    v_mfma_f32_4x4x4_16b_bf16 v[48:51], v[40:41], v[80:81], v[48:51]
    v_mfma_f32_4x4x4_16b_bf16 v[52:55], v[40:41], v[82:83], v[52:55]
    v_and_b32 v40, v20, v4
    v_and_b32 v41, v20, v5
    s_waitcnt vmcnt(4)
    v_mfma_f32_4x4x4_16b_bf16 v[48:51], v[42:43], v[112:113], v[48:51]
    v_mfma_f32_4x4x4_16b_bf16 v[52:55], v[42:43], v[114:115], v[52:55]
    v_and_b32 v42, v21, v4
    v_and_b32 v43, v21, v5
    s_waitcnt vmcnt(3)
    v_mfma_f32_4x4x4_16b_bf16 v[48:51], v[40:41], v[144:145], v[48:51]
    v_mfma_f32_4x4x4_16b_bf16 v[52:55], v[40:41], v[146:147], v[52:55]
    v_and_b32 v40, v22, v4
    v_and_b32 v41, v22, v5
    s_waitcnt vmcnt(2)
    v_mfma_f32_4x4x4_16b_bf16 v[48:51], v[42:43], v[176:177], v[48:51]
    v_mfma_f32_4x4x4_16b_bf16 v[52:55], v[42:43], v[178:179], v[52:55]
    v_and_b32 v42, v23, v4
    v_and_b32 v43, v23, v5
    s_waitcnt vmcnt(1)
    v_mfma_f32_4x4x4_16b_bf16 v[48:51], v[40:41], v[208:209], v[48:51]
    v_mfma_f32_4x4x4_16b_bf16 v[52:55], v[40:41], v[210:211], v[52:55]
    s_waitcnt vmcnt(0)
    v_mfma_f32_4x4x4_16b_bf16 v[48:51], v[42:43], v[84:85], v[48:51]
    v_mfma_f32_4x4x4_16b_bf16 v[52:55], v[42:43], v[86:87], v[52:55]
    s_nop 4
    v_permlane32_swap_b32 v48, v52
    v_permlane32_swap_b32 v49, v53
    v_permlane32_swap_b32 v50, v54
    v_permlane32_swap_b32 v51, v55
    v_add_f32 v48, v48, v52
    v_add_f32 v49, v49, v53
    v_add_f32 v50, v50, v54
    v_add_f32 v51, v51, v55
    s_nop 0
    v_permlane16_swap_b32 v48, v50
    v_permlane16_swap_b32 v49, v51
    v_add_f32 v48, v48, v50
    v_add_f32 v49, v49, v51
    s_nop 0
    v_add_f32_dpp v48, v48, v48 row_ror:8 row_mask:0xf bank_mask:0xf
    v_add_f32_dpp v49, v49, v49 row_ror:8 row_mask:0xf bank_mask:0xf
    s_mov_b64 exec, s[30:31]
    buffer_store_dwordx2 v[48:49], v12, s[40:43], s93 offen sc1
    s_mov_b64 exec, -1
    s_branch L_ffn_nod3
L_ffn_d7:
    s_mul_i32 s94, s90, 2304
    s_add_u32 s94, s94, 591872
    v_and_b32 v40, v16, v4
    v_and_b32 v41, v16, v5
    v_and_b32 v42, v17, v4
    v_and_b32 v43, v17, v5
    v_mfma_f32_4x4x4_16b_bf16 v[48:51], v[40:41], v[200:201], 0
    v_mfma_f32_4x4x4_16b_bf16 v[52:55], v[40:41], v[202:203], 0
    v_mfma_f32_4x4x4_16b_bf16 v[24:27], v[40:41], v[228:229], 0
    v_mfma_f32_4x4x4_16b_bf16 v[28:31], v[40:41], v[230:231], 0
    v_and_b32 v40, v18, v4
    v_and_b32 v41, v18, v5
    v_mfma_f32_4x4x4_16b_bf16 v[48:51], v[42:43], v[204:205], v[48:51]
    v_mfma_f32_4x4x4_16b_bf16 v[52:55], v[42:43], v[206:207], v[52:55]
    v_mfma_f32_4x4x4_16b_bf16 v[24:27], v[42:43], v[116:117], v[24:27]
    v_mfma_f32_4x4x4_16b_bf16 v[28:31], v[42:43], v[118:119], v[28:31]
    v_and_b32 v42, v19, v4
    v_and_b32 v43, v19, v5
    v_mfma_f32_4x4x4_16b_bf16 v[48:51], v[40:41], v[80:81], v[48:51]
    v_mfma_f32_4x4x4_16b_bf16 v[52:55], v[40:41], v[82:83], v[52:55]
    v_mfma_f32_4x4x4_16b_bf16 v[24:27], v[40:41], v[148:149], v[24:27]
    v_mfma_f32_4x4x4_16b_bf16 v[28:31], v[40:41], v[150:151], v[28:31]
    v_and_b32 v40, v20, v4
    v_and_b32 v41, v20, v5
    v_mfma_f32_4x4x4_16b_bf16 v[48:51], v[42:43], v[112:113], v[48:51]
    v_mfma_f32_4x4x4_16b_bf16 v[52:55], v[42:43], v[114:115], v[52:55]
    v_mfma_f32_4x4x4_16b_bf16 v[24:27], v[42:43], v[180:181], v[24:27]
    v_mfma_f32_4x4x4_16b_bf16 v[28:31], v[42:43], v[182:183], v[28:31]
    v_and_b32 v42, v21, v4
    v_and_b32 v43, v21, v5
    v_mfma_f32_4x4x4_16b_bf16 v[48:51], v[40:41], v[144:145], v[48:51]
    v_mfma_f32_4x4x4_16b_bf16 v[52:55], v[40:41], v[146:147], v[52:55]
    v_mfma_f32_4x4x4_16b_bf16 v[24:27], v[40:41], v[212:213], v[24:27]
    v_mfma_f32_4x4x4_16b_bf16 v[28:31], v[40:41], v[214:215], v[28:31]
    v_and_b32 v40, v22, v4
    v_and_b32 v41, v22, v5
    v_mfma_f32_4x4x4_16b_bf16 v[48:51], v[42:43], v[176:177], v[48:51]
    v_mfma_f32_4x4x4_16b_bf16 v[52:55], v[42:43], v[178:179], v[52:55]
    v_mfma_f32_4x4x4_16b_bf16 v[24:27], v[42:43], v[244:245], v[24:27]
    v_mfma_f32_4x4x4_16b_bf16 v[28:31], v[42:43], v[246:247], v[28:31]
    v_and_b32 v42, v23, v4
    v_and_b32 v43, v23, v5
    v_mfma_f32_4x4x4_16b_bf16 v[48:51], v[40:41], v[208:209], v[48:51]
    v_mfma_f32_4x4x4_16b_bf16 v[52:55], v[40:41], v[210:211], v[52:55]
    v_mfma_f32_4x4x4_16b_bf16 v[24:27], v[40:41], v[88:89], v[24:27]
    v_mfma_f32_4x4x4_16b_bf16 v[28:31], v[40:41], v[90:91], v[28:31]
    v_mfma_f32_4x4x4_16b_bf16 v[48:51], v[42:43], v[84:85], v[48:51]
    v_mfma_f32_4x4x4_16b_bf16 v[52:55], v[42:43], v[86:87], v[52:55]
    v_mfma_f32_4x4x4_16b_bf16 v[24:27], v[42:43], v[120:121], v[24:27]
    v_mfma_f32_4x4x4_16b_bf16 v[28:31], v[42:43], v[122:123], v[28:31]
    s_nop 2
    v_permlane32_swap_b32 v48, v52
    v_permlane32_swap_b32 v49, v53
    v_permlane32_swap_b32 v50, v54
    v_permlane32_swap_b32 v51, v55
    v_permlane32_swap_b32 v24, v28
    v_permlane32_swap_b32 v25, v29
    v_permlane32_swap_b32 v26, v30
    v_permlane32_swap_b32 v27, v31
    v_add_f32 v48, v48, v52
    v_add_f32 v49, v49, v53
    v_add_f32 v50, v50, v54
    v_add_f32 v51, v51, v55
    v_add_f32 v24, v24, v28
    v_add_f32 v25, v25, v29
    v_add_f32 v26, v26, v30
    v_add_f32 v27, v27, v31
    v_permlane16_swap_b32 v48, v50
    v_permlane16_swap_b32 v49, v51
    v_permlane16_swap_b32 v24, v26
    v_permlane16_swap_b32 v25, v27
    v_add_f32 v48, v48, v50
    v_add_f32 v49, v49, v51
    v_add_f32 v24, v24, v26
    v_add_f32 v25, v25, v27
    v_add_f32_dpp v48, v48, v48 row_ror:8 row_mask:0xf bank_mask:0xf
    v_add_f32_dpp v49, v49, v49 row_ror:8 row_mask:0xf bank_mask:0xf
    v_add_f32_dpp v24, v24, v24 row_ror:8 row_mask:0xf bank_mask:0xf
    v_add_f32_dpp v25, v25, v25 row_ror:8 row_mask:0xf bank_mask:0xf
    s_mov_b64 exec, s[30:31]
    buffer_store_dwordx2 v[48:49], v12, s[40:43], s93 offen sc1
    buffer_store_dwordx2 v[24:25], v12, s[40:43], s94 offen sc1
    s_mov_b64 exec, -1
L_ffn_nod3:
    s_barrier
    s_cmp_eq_u32 s81, 6
    s_cbranch_scc0 L_fin
    s_cmp_lt_u32 s90, 36
    s_cbranch_scc0 L_fin
    v_lshrrev_b32 v1, 2, v0
    v_mul_u32_u24 v2, 2304, v1
    v_and_b32 v3, 3, v0
    v_lshl_add_u32 v2, v3, 4, v2
    v_cmp_gt_u32 vcc, 8, v1
    v_mov_b32 v8, 0x7ffffff0
    s_nop 0
    v_cndmask_b32 v8, v8, v2, vcc
    v_lshlrev_b32 v9, 4, v3
    s_lshl_b32 s30, s90, 6
    v_add_u32 v9, s30, v9
    v_lshrrev_b32 v10, 1, v9
    ds_read_b128 v[40:43], v9 offset:5888
    s_add_u32 s92, s30, 589824
    s_add_u32 s93, s92, 36864
    s_add_u32 s94, s92, 73728
    s_add_u32 s95, s92, 110592
    s_add_u32 s96, s92, 147456
    buffer_load_dwordx4 v[64:67], v2, s[40:43], s92 offen sc1
    buffer_load_dwordx4 v[68:71], v2, s[40:43], s93 offen sc1
    buffer_load_dwordx4 v[72:75], v2, s[40:43], s94 offen sc1
    buffer_load_dwordx4 v[76:79], v2, s[40:43], s95 offen sc1
    buffer_load_dwordx4 v[80:83], v8, s[40:43], s96 offen sc1
    buffer_load_dwordx4 v[84:87], v2, s[40:43], s92 offen sc1
    buffer_load_dwordx4 v[88:91], v2, s[40:43], s93 offen sc1
    buffer_load_dwordx4 v[92:95], v2, s[40:43], s94 offen sc1
    buffer_load_dwordx4 v[96:99], v2, s[40:43], s95 offen sc1
    buffer_load_dwordx4 v[100:103], v8, s[40:43], s96 offen sc1
    buffer_load_dwordx4 v[104:107], v2, s[40:43], s92 offen sc1
    buffer_load_dwordx4 v[108:111], v2, s[40:43], s93 offen sc1
    buffer_load_dwordx4 v[112:115], v2, s[40:43], s94 offen sc1
    buffer_load_dwordx4 v[116:119], v2, s[40:43], s95 offen sc1
    buffer_load_dwordx4 v[120:123], v8, s[40:43], s96 offen sc1
    s_mov_b32 s83, 50000
L_t3poll:
    s_waitcnt vmcnt(13)
    v_pk_add_f32 v[16:17], v[64:65], v[68:69]
    v_pk_add_f32 v[18:19], v[66:67], v[70:71]
    s_waitcnt vmcnt(12)
    v_pk_add_f32 v[16:17], v[16:17], v[72:73]
    v_pk_add_f32 v[18:19], v[18:19], v[74:75]
    s_waitcnt vmcnt(11)
    v_pk_add_f32 v[16:17], v[16:17], v[76:77]
    v_pk_add_f32 v[18:19], v[18:19], v[78:79]
    s_waitcnt vmcnt(10)
    v_pk_add_f32 v[16:17], v[16:17], v[80:81]
    v_pk_add_f32 v[18:19], v[18:19], v[82:83]
    v_add_f32 v24, v16, v17
    v_add_f32 v25, v18, v19
    v_add_f32 v24, v24, v25
    v_cmp_u_f32 vcc, v24, v24
    s_nop 4
    s_cbranch_vccz L_t3poll_ok
    buffer_load_dwordx4 v[64:67], v2, s[40:43], s92 offen sc1
    buffer_load_dwordx4 v[68:71], v2, s[40:43], s93 offen sc1
    buffer_load_dwordx4 v[72:75], v2, s[40:43], s94 offen sc1
    buffer_load_dwordx4 v[76:79], v2, s[40:43], s95 offen sc1
    buffer_load_dwordx4 v[80:83], v8, s[40:43], s96 offen sc1
    s_waitcnt vmcnt(13)
    v_pk_add_f32 v[16:17], v[84:85], v[88:89]
    v_pk_add_f32 v[18:19], v[86:87], v[90:91]
    s_waitcnt vmcnt(12)
    v_pk_add_f32 v[16:17], v[16:17], v[92:93]
    v_pk_add_f32 v[18:19], v[18:19], v[94:95]
    s_waitcnt vmcnt(11)
    v_pk_add_f32 v[16:17], v[16:17], v[96:97]
    v_pk_add_f32 v[18:19], v[18:19], v[98:99]
    s_waitcnt vmcnt(10)
    v_pk_add_f32 v[16:17], v[16:17], v[100:101]
    v_pk_add_f32 v[18:19], v[18:19], v[102:103]
    v_add_f32 v24, v16, v17
    v_add_f32 v25, v18, v19
    v_add_f32 v24, v24, v25
    v_cmp_u_f32 vcc, v24, v24
    s_nop 4
    s_cbranch_vccz L_t3poll_ok
    buffer_load_dwordx4 v[84:87], v2, s[40:43], s92 offen sc1
    buffer_load_dwordx4 v[88:91], v2, s[40:43], s93 offen sc1
    buffer_load_dwordx4 v[92:95], v2, s[40:43], s94 offen sc1
    buffer_load_dwordx4 v[96:99], v2, s[40:43], s95 offen sc1
    buffer_load_dwordx4 v[100:103], v8, s[40:43], s96 offen sc1
    s_waitcnt vmcnt(13)
    v_pk_add_f32 v[16:17], v[104:105], v[108:109]
    v_pk_add_f32 v[18:19], v[106:107], v[110:111]
    s_waitcnt vmcnt(12)
    v_pk_add_f32 v[16:17], v[16:17], v[112:113]
    v_pk_add_f32 v[18:19], v[18:19], v[114:115]
    s_waitcnt vmcnt(11)
    v_pk_add_f32 v[16:17], v[16:17], v[116:117]
    v_pk_add_f32 v[18:19], v[18:19], v[118:119]
    s_waitcnt vmcnt(10)
    v_pk_add_f32 v[16:17], v[16:17], v[120:121]
    v_pk_add_f32 v[18:19], v[18:19], v[122:123]
    v_add_f32 v24, v16, v17
    v_add_f32 v25, v18, v19
    v_add_f32 v24, v24, v25
    v_cmp_u_f32 vcc, v24, v24
    s_nop 4
    s_cbranch_vccz L_t3poll_ok
    buffer_load_dwordx4 v[104:107], v2, s[40:43], s92 offen sc1
    buffer_load_dwordx4 v[108:111], v2, s[40:43], s93 offen sc1
    buffer_load_dwordx4 v[112:115], v2, s[40:43], s94 offen sc1
    buffer_load_dwordx4 v[116:119], v2, s[40:43], s95 offen sc1
    buffer_load_dwordx4 v[120:123], v8, s[40:43], s96 offen sc1
    s_sub_u32 s83, s83, 1
    s_cmp_lg_u32 s83, 0
    s_cbranch_scc1 L_t3poll
L_t3poll_ok:
    v_add_f32_dpp v16, v16, v16 row_ror:8 row_mask:0xf bank_mask:0xf
    v_add_f32_dpp v17, v17, v17 row_ror:8 row_mask:0xf bank_mask:0xf
    v_add_f32_dpp v18, v18, v18 row_ror:8 row_mask:0xf bank_mask:0xf
    v_add_f32_dpp v19, v19, v19 row_ror:8 row_mask:0xf bank_mask:0xf
    v_add_f32_dpp v16, v16, v16 row_ror:4 row_mask:0xf bank_mask:0xf
    v_add_f32_dpp v17, v17, v17 row_ror:4 row_mask:0xf bank_mask:0xf
    v_add_f32_dpp v18, v18, v18 row_ror:4 row_mask:0xf bank_mask:0xf
    v_add_f32_dpp v19, v19, v19 row_ror:4 row_mask:0xf bank_mask:0xf
    v_mov_b32 v20, v16
    v_mov_b32 v21, v17
    v_mov_b32 v22, v18
    v_mov_b32 v23, v19
    v_permlane16_swap_b32 v16, v20
    v_permlane16_swap_b32 v17, v21
    v_permlane16_swap_b32 v18, v22
    v_permlane16_swap_b32 v19, v23
    v_add_f32 v16, v16, v20
    v_add_f32 v17, v17, v21
    v_add_f32 v18, v18, v22
    v_add_f32 v19, v19, v23
    v_mov_b32 v20, v16
    v_mov_b32 v21, v17
    v_mov_b32 v22, v18
    v_mov_b32 v23, v19
    v_permlane32_swap_b32 v16, v20
    v_permlane32_swap_b32 v17, v21
    v_permlane32_swap_b32 v18, v22
    v_permlane32_swap_b32 v19, v23
    v_add_f32 v16, v16, v20
    v_add_f32 v17, v17, v21
    v_add_f32 v18, v18, v22
    v_add_f32 v19, v19, v23
    v_cvt_pk_bf16_f32 v16, 0, v16
    v_cvt_pk_bf16_f32 v17, 0, v17
    v_cvt_pk_bf16_f32 v18, 0, v18
    v_cvt_pk_bf16_f32 v19, 0, v19
    v_lshlrev_b32 v20, 16, v252
    v_and_b32 v21, 0xffff0000, v252
    v_lshlrev_b32 v22, 16, v254
    v_and_b32 v23, 0xffff0000, v254
    s_waitcnt lgkmcnt(0)
    v_pk_mul_f32 v[16:17], v[16:17], v[20:21]
    v_pk_mul_f32 v[18:19], v[18:19], v[22:23]
    v_cvt_pk_bf16_f32 v16, 0, v16
    v_cvt_pk_bf16_f32 v17, 0, v17
    v_cvt_pk_bf16_f32 v18, 0, v18
    v_cvt_pk_bf16_f32 v19, 0, v19
    v_pk_add_f32 v[16:17], v[16:17], v[40:41]
    v_pk_add_f32 v[18:19], v[18:19], v[42:43]
    v_cvt_pk_bf16_f32 v16, v16, v17
    v_cvt_pk_bf16_f32 v17, v18, v19
    s_mov_b64 exec, 0xf
    buffer_store_dwordx2 v[16:17], v10, s[76:79], 0 offen
    s_mov_b64 exec, -1
L_fin:
    s_cmp_eq_u32 s2, 0
    s_cbranch_scc0 L_fin2
    s_cmp_eq_u32 s81, 7
    s_cbranch_scc0 L_fin2
    s_load_dword s30, s[28:29], 0
    s_waitcnt lgkmcnt(0)
    s_add_u32 s30, s30, 1
    v_mov_b32 v16, s30
    v_mov_b32 v17, 0
    s_mov_b64 exec, 1
    buffer_store_dword v16, v17, s[40:43], 0 offen sc1
    s_mov_b64 exec, -1
L_fin2:
    s_endpgm
L_service:
    s_setprio 3
    v_lshlrev_b32 v1, 1, v0
    v_lshlrev_b32 v3, 3, v0
    v_lshlrev_b32 v2, 2, v0
    v_lshlrev_b32 v8, 4, v0
    v_bfe_u32 v9, v0, 3, 1
    v_lshrrev_b32 v10, 4, v0
    v_lshl_add_u32 v9, v9, 2, v10
    v_and_b32 v10, 7, v0
    v_lshlrev_b32 v10, 4, v10
    v_mul_u32_u24 v11, 6912, v9
    v_add_u32 v11, v11, v10
    v_lshl_add_u32 v12, v9, 13, v10
    v_mul_u32_u24 v13, 80, v9
    s_and_b32 s92, s91, 3
    s_lshr_b32 s93, s91, 2
    s_mul_i32 s94, s92, 288
    s_mul_i32 s95, s92, 995328
    s_lshl_b32 s96, s93, 7
    s_add_u32 s95, s95, s96
    s_waitcnt lgkmcnt(0)
    s_mov_b32 s48, s22
    s_and_b32 s49, s23, 0xffff
    s_mov_b32 s50, 1152
    s_mov_b32 s51, 0x20000
    s_mov_b32 s52, s24
    s_and_b32 s53, s25, 0xffff
    s_mov_b32 s54, 3981312
    s_mov_b32 s55, 0x20000
    s_cmp_lt_i32 s91, 0
    s_cbranch_scc1 L_sv_nop1a
    buffer_load_ushort v216, v1, s[48:51], s94 offen offset:0
    buffer_load_ushort v217, v1, s[48:51], s94 offen offset:128
    buffer_load_ushort v218, v1, s[48:51], s94 offen offset:256
    buffer_load_dwordx4 v[64:67], v11, s[52:55], s95 offen nt
    s_add_u32 s95, s95, 55296
    buffer_load_dwordx4 v[68:71], v11, s[52:55], s95 offen nt
    s_add_u32 s95, s95, 55296
    buffer_load_dwordx4 v[72:75], v11, s[52:55], s95 offen nt
    s_add_u32 s95, s95, 55296
    buffer_load_dwordx4 v[76:79], v11, s[52:55], s95 offen nt
    s_add_u32 s95, s95, 55296
    buffer_load_dwordx4 v[80:83], v11, s[52:55], s95 offen nt
    s_add_u32 s95, s95, 55296
    buffer_load_dwordx4 v[84:87], v11, s[52:55], s95 offen nt
    s_add_u32 s95, s95, 55296
    buffer_load_dwordx4 v[88:91], v11, s[52:55], s95 offen nt
    s_add_u32 s95, s95, 55296
    buffer_load_dwordx4 v[92:95], v11, s[52:55], s95 offen nt
    s_add_u32 s95, s95, 55296
    buffer_load_dwordx4 v[96:99], v11, s[52:55], s95 offen nt
    s_add_u32 s95, s95, 55296
    buffer_load_dwordx4 v[100:103], v11, s[52:55], s95 offen nt
    s_add_u32 s95, s95, 55296
    buffer_load_dwordx4 v[104:107], v11, s[52:55], s95 offen nt
    s_add_u32 s95, s95, 55296
    buffer_load_dwordx4 v[108:111], v11, s[52:55], s95 offen nt
    s_add_u32 s95, s95, 55296
    buffer_load_dwordx4 v[112:115], v11, s[52:55], s95 offen nt
    s_add_u32 s95, s95, 55296
    buffer_load_dwordx4 v[116:119], v11, s[52:55], s95 offen nt
    s_add_u32 s95, s95, 55296
    buffer_load_dwordx4 v[120:123], v11, s[52:55], s95 offen nt
    s_add_u32 s95, s95, 55296
    buffer_load_dwordx4 v[124:127], v11, s[52:55], s95 offen nt
    s_add_u32 s95, s95, 55296
    buffer_load_dwordx4 v[128:131], v11, s[52:55], s95 offen nt
    s_add_u32 s95, s95, 55296
    buffer_load_dwordx4 v[132:135], v11, s[52:55], s95 offen nt
L_sv_nop1a:
    v_mov_b32 v56, 42
    v_mov_b32 v57, 0
    v_mov_b32 v58, 0
    v_mov_b32 v59, 0
    ds_write_b128 v57, v[56:59] offset:2592
    ds_write_b32 v57, v57 offset:2608
    s_waitcnt lgkmcnt(0)
    s_load_dword s80, s[28:29], 0
    v_mov_b32 v56, 0
    v_mov_b32 v57, 0
    v_mov_b32 v58, 0
    v_mov_b32 v59, 0
    ds_write_b128 v8, v[56:59] offset:49152
    ds_write_b128 v8, v[56:59] offset:50176
    ds_write_b128 v8, v[56:59] offset:51200
    s_mov_b32 s44, s4
    s_and_b32 s45, s5, 0xffff
    s_mov_b32 s46, 1152
    s_mov_b32 s47, 0x20000
    s_mov_b32 s56, s10
    s_and_b32 s57, s11, 0xffff
    s_mov_b32 s58, 4718592
    s_mov_b32 s59, 0x20000
    buffer_load_dwordx2 v[208:209], v3, s[44:47], 0 offen offset:0
    buffer_load_dwordx2 v[210:211], v3, s[44:47], 0 offen offset:512
    buffer_load_dwordx2 v[212:213], v3, s[44:47], 0 offen offset:1024
    s_lshr_b32 s96, s88, 2
    s_mul_i32 s97, s96, 288
    buffer_load_dword v214, v2, s[44:47], s97 offen
    buffer_load_dword v215, v2, s[44:47], s97 offen offset:256
    s_mul_i32 s98, s96, 1179648
    s_lshl_b32 s99, s87, 9
    s_add_u32 s98, s98, s99
    s_and_b32 s99, s88, 3
    s_lshl_b32 s99, s99, 7
    s_add_u32 s98, s98, s99
    buffer_load_dwordx4 v[136:139], v12, s[56:59], s98 offen nt
    s_add_u32 s98, s98, 65536
    buffer_load_dwordx4 v[140:143], v12, s[56:59], s98 offen nt
    s_add_u32 s98, s98, 65536
    buffer_load_dwordx4 v[144:147], v12, s[56:59], s98 offen nt
    s_add_u32 s98, s98, 65536
    buffer_load_dwordx4 v[148:151], v12, s[56:59], s98 offen nt
    s_add_u32 s98, s98, 65536
    buffer_load_dwordx4 v[152:155], v12, s[56:59], s98 offen nt
    s_add_u32 s98, s98, 65536
    buffer_load_dwordx4 v[156:159], v12, s[56:59], s98 offen nt
    s_add_u32 s98, s98, 65536
    buffer_load_dwordx4 v[160:163], v12, s[56:59], s98 offen nt
    s_add_u32 s98, s98, 65536
    buffer_load_dwordx4 v[164:167], v12, s[56:59], s98 offen nt
    s_add_u32 s98, s98, 65536
    buffer_load_dwordx4 v[168:171], v12, s[56:59], s98 offen nt
    s_add_u32 s98, s98, 65536
    buffer_load_dwordx4 v[172:175], v12, s[56:59], s98 offen nt
    s_add_u32 s98, s98, 65536
    buffer_load_dwordx4 v[176:179], v12, s[56:59], s98 offen nt
    s_add_u32 s98, s98, 65536
    buffer_load_dwordx4 v[180:183], v12, s[56:59], s98 offen nt
    s_add_u32 s98, s98, 65536
    buffer_load_dwordx4 v[184:187], v12, s[56:59], s98 offen nt
    s_add_u32 s98, s98, 65536
    buffer_load_dwordx4 v[188:191], v12, s[56:59], s98 offen nt
    s_add_u32 s98, s98, 65536
    buffer_load_dwordx4 v[192:195], v12, s[56:59], s98 offen nt
    s_add_u32 s98, s98, 65536
    buffer_load_dwordx4 v[196:199], v12, s[56:59], s98 offen nt
    s_add_u32 s98, s98, 65536
    buffer_load_dwordx4 v[200:203], v12, s[56:59], s98 offen nt
    s_add_u32 s98, s98, 65536
    buffer_load_dwordx4 v[204:207], v12, s[56:59], s98 offen nt
    s_barrier
    s_mov_b32 s40, s28
    s_and_b32 s41, s29, 0xffff
    s_mov_b32 s42, 2097152
    s_mov_b32 s43, 0x20000
    v_and_b32 v58, 1, v0
    v_mov_b32 v56, 0xffff
    v_mov_b32 v57, 0xffff0000
    v_cmp_eq_u32 vcc, 1, v58
    s_nop 1
    v_cndmask_b32 v56, v56, v57, vcc
    v_bfe_u32 v58, v0, 1, 2
    v_cmp_eq_u32 vcc, 0, v58
    s_nop 1
    v_cndmask_b32 v4, 0, v56, vcc
    v_cmp_eq_u32 vcc, 1, v58
    s_nop 1
    v_cndmask_b32 v5, 0, v56, vcc
    v_cmp_eq_u32 vcc, 2, v58
    s_nop 1
    v_cndmask_b32 v6, 0, v56, vcc
    v_cmp_eq_u32 vcc, 3, v58
    s_nop 1
    v_cndmask_b32 v7, 0, v56, vcc
    s_waitcnt lgkmcnt(0)
    s_mul_i32 s80, s80, 0x9E3779B1
    s_add_u32 s80, s80, 0x7F4A7C15
    v_and_b32 v15, 7, v0
    v_lshlrev_b32 v15, 6, v15
    v_lshrrev_b32 v56, 4, v0
    v_lshl_add_u32 v15, v56, 5, v15
    v_and_b32 v56, 7, v0
    v_mul_u32_u24 v56, 80, v56
    v_lshrrev_b32 v57, 3, v0
    v_lshl_add_u32 v56, v57, 2, v56
    s_cmp_lt_i32 s91, 0
    s_nop 0
    s_cbranch_scc1 L_sv_nop1b
    s_waitcnt vmcnt(41)
    v_lshlrev_b32 v216, 16, v216
    v_mul_f32 v52, s86, v216
    v_exp_f32 v52, -v52
    s_nop 0
    v_add_f32 v52, 1.0, v52
    v_rcp_f32 v58, v52
    s_nop 0
    v_mul_f32 v59, v58, v216
    v_fma_f32 v52, -v59, v52, v216
    v_fma_f32 v52, v52, v58, v59
    v_cvt_pk_bf16_f32 v52, v52, v52
    v_lshlrev_b32 v217, 16, v217
    v_mul_f32 v53, s86, v217
    v_exp_f32 v53, -v53
    s_nop 0
    v_add_f32 v53, 1.0, v53
    v_rcp_f32 v58, v53
    s_nop 0
    v_mul_f32 v59, v58, v217
    v_fma_f32 v53, -v59, v53, v217
    v_fma_f32 v53, v53, v58, v59
    v_cvt_pk_bf16_f32 v53, v53, v53
    v_lshlrev_b32 v218, 16, v218
    v_mul_f32 v54, s86, v218
    v_exp_f32 v54, -v54
    s_nop 0
    v_add_f32 v54, 1.0, v54
    v_rcp_f32 v58, v54
    s_nop 0
    v_mul_f32 v59, v58, v218
    v_fma_f32 v54, -v59, v54, v218
    v_fma_f32 v54, v54, v58, v59
    v_cvt_pk_bf16_f32 v54, v54, v54
    ds_write_b32 v56, v52 offset:3328
    ds_write_b32 v56, v53 offset:3360
    s_mov_b64 exec, 0xffff
    ds_write_b32 v56, v54 offset:3392
    s_mov_b64 exec, -1
    s_waitcnt lgkmcnt(0)
    ds_read_b128 v[16:19], v13 offset:3328
    ds_read_b128 v[20:23], v13 offset:3344
    ds_read_b128 v[24:27], v13 offset:3360
    ds_read_b128 v[28:31], v13 offset:3376
    ds_read_b128 v[32:35], v13 offset:3392
    s_waitcnt lgkmcnt(0)
    v_and_b32 v40, v16, v4
    v_and_b32 v41, v16, v5
    v_and_b32 v42, v16, v6
    v_and_b32 v43, v16, v7
    v_and_b32 v44, v17, v4
    v_and_b32 v45, v17, v5
    v_and_b32 v46, v17, v6
    v_and_b32 v47, v17, v7
    s_waitcnt vmcnt(38)
    v_mfma_f32_16x16x32_bf16 v[48:51], v[40:43], v[64:67], 0
    v_and_b32 v40, v18, v4
    v_and_b32 v41, v18, v5
    v_and_b32 v42, v18, v6
    v_and_b32 v43, v18, v7
    v_mfma_f32_16x16x32_bf16 v[48:51], v[44:47], v[68:71], v[48:51]
    v_and_b32 v44, v19, v4
    v_and_b32 v45, v19, v5
    v_and_b32 v46, v19, v6
    v_and_b32 v47, v19, v7
    v_mfma_f32_16x16x32_bf16 v[48:51], v[40:43], v[72:75], v[48:51]
    v_and_b32 v40, v20, v4
    v_and_b32 v41, v20, v5
    v_and_b32 v42, v20, v6
    v_and_b32 v43, v20, v7
    s_waitcnt vmcnt(35)
    v_mfma_f32_16x16x32_bf16 v[48:51], v[44:47], v[76:79], v[48:51]
    v_and_b32 v44, v21, v4
    v_and_b32 v45, v21, v5
    v_and_b32 v46, v21, v6
    v_and_b32 v47, v21, v7
    v_mfma_f32_16x16x32_bf16 v[48:51], v[40:43], v[80:83], v[48:51]
    v_and_b32 v40, v22, v4
    v_and_b32 v41, v22, v5
    v_and_b32 v42, v22, v6
    v_and_b32 v43, v22, v7
    v_mfma_f32_16x16x32_bf16 v[48:51], v[44:47], v[84:87], v[48:51]
    v_and_b32 v44, v23, v4
    v_and_b32 v45, v23, v5
    v_and_b32 v46, v23, v6
    v_and_b32 v47, v23, v7
    s_waitcnt vmcnt(32)
    v_mfma_f32_16x16x32_bf16 v[48:51], v[40:43], v[88:91], v[48:51]
    v_and_b32 v40, v24, v4
    v_and_b32 v41, v24, v5
    v_and_b32 v42, v24, v6
    v_and_b32 v43, v24, v7
    v_mfma_f32_16x16x32_bf16 v[48:51], v[44:47], v[92:95], v[48:51]
    v_and_b32 v44, v25, v4
    v_and_b32 v45, v25, v5
    v_and_b32 v46, v25, v6
    v_and_b32 v47, v25, v7
    v_mfma_f32_16x16x32_bf16 v[48:51], v[40:43], v[96:99], v[48:51]
    v_and_b32 v40, v26, v4
    v_and_b32 v41, v26, v5
    v_and_b32 v42, v26, v6
    v_and_b32 v43, v26, v7
    s_waitcnt vmcnt(29)
    v_mfma_f32_16x16x32_bf16 v[48:51], v[44:47], v[100:103], v[48:51]
    v_and_b32 v44, v27, v4
    v_and_b32 v45, v27, v5
    v_and_b32 v46, v27, v6
    v_and_b32 v47, v27, v7
    v_mfma_f32_16x16x32_bf16 v[48:51], v[40:43], v[104:107], v[48:51]
    v_and_b32 v40, v28, v4
    v_and_b32 v41, v28, v5
    v_and_b32 v42, v28, v6
    v_and_b32 v43, v28, v7
    v_mfma_f32_16x16x32_bf16 v[48:51], v[44:47], v[108:111], v[48:51]
    v_and_b32 v44, v29, v4
    v_and_b32 v45, v29, v5
    v_and_b32 v46, v29, v6
    v_and_b32 v47, v29, v7
    s_waitcnt vmcnt(26)
    v_mfma_f32_16x16x32_bf16 v[48:51], v[40:43], v[112:115], v[48:51]
    v_and_b32 v40, v30, v4
    v_and_b32 v41, v30, v5
    v_and_b32 v42, v30, v6
    v_and_b32 v43, v30, v7
    v_mfma_f32_16x16x32_bf16 v[48:51], v[44:47], v[116:119], v[48:51]
    v_and_b32 v44, v31, v4
    v_and_b32 v45, v31, v5
    v_and_b32 v46, v31, v6
    v_and_b32 v47, v31, v7
    v_mfma_f32_16x16x32_bf16 v[48:51], v[40:43], v[120:123], v[48:51]
    v_and_b32 v40, v32, v4
    v_and_b32 v41, v32, v5
    v_and_b32 v42, v32, v6
    v_and_b32 v43, v32, v7
    s_waitcnt vmcnt(23)
    v_mfma_f32_16x16x32_bf16 v[48:51], v[44:47], v[124:127], v[48:51]
    v_and_b32 v44, v33, v4
    v_and_b32 v45, v33, v5
    v_and_b32 v46, v33, v6
    v_and_b32 v47, v33, v7
    v_mfma_f32_16x16x32_bf16 v[48:51], v[40:43], v[128:131], v[48:51]
    s_nop 0
    v_mfma_f32_16x16x32_bf16 v[48:51], v[44:47], v[132:135], v[48:51]
    s_nop 7
    v_mov_b32 v52, v48
    v_mov_b32 v53, v49
    v_mov_b32 v54, v50
    v_mov_b32 v55, v51
    v_permlane32_swap_b32 v48, v52
    v_permlane32_swap_b32 v49, v53
    v_permlane32_swap_b32 v50, v54
    v_permlane32_swap_b32 v51, v55
    v_add_f32_dpp v48, v52, v48 row_ror:8 row_mask:0xf bank_mask:0xf
    v_add_f32_dpp v49, v53, v49 row_ror:8 row_mask:0xf bank_mask:0xf
    v_add_f32_dpp v50, v54, v50 row_ror:8 row_mask:0xf bank_mask:0xf
    v_add_f32_dpp v51, v55, v51 row_ror:8 row_mask:0xf bank_mask:0xf
    v_mov_b32 v240, v48
    v_mov_b32 v241, s80
    v_mov_b32 v242, v49
    v_mov_b32 v243, s80
    v_mov_b32 v244, v50
    v_mov_b32 v245, s80
    v_mov_b32 v246, v51
    v_mov_b32 v247, s80
    s_and_b32 s92, s91, 3
    s_mul_i32 s92, s92, 27648
    s_lshr_b32 s93, s91, 2
    s_lshl_b32 s93, s93, 9
    s_add_u32 s92, s92, s93
    s_add_u32 s92, s92, 4096
    s_mov_b32 s30, 0x00ff00ff
    s_mov_b32 s31, 0
    s_mov_b64 exec, s[30:31]
    buffer_store_dwordx4 v[240:243], v15, s[40:43], s92 offen sc1
    buffer_store_dwordx4 v[244:247], v15, s[40:43], s92 offen offset:16 sc1
    s_mov_b64 exec, -1
    s_nop 0
L_sv_nop1b:
    s_waitcnt vmcnt(18)
    v_lshlrev_b32 v220, 16, v208
    v_and_b32 v221, 0xffff0000, v208
    v_lshlrev_b32 v222, 16, v209
    v_and_b32 v223, 0xffff0000, v209
    v_lshlrev_b32 v224, 16, v210
    v_and_b32 v225, 0xffff0000, v210
    v_lshlrev_b32 v226, 16, v211
    v_and_b32 v227, 0xffff0000, v211
    v_lshlrev_b32 v228, 16, v212
    v_and_b32 v229, 0xffff0000, v212
    v_lshlrev_b32 v230, 16, v213
    v_and_b32 v231, 0xffff0000, v213
    v_add_f32 v56, v220, v221
    v_add_f32 v56, v56, v222
    v_add_f32 v56, v56, v223
    v_add_f32 v56, v56, v224
    v_add_f32 v56, v56, v225
    v_add_f32 v56, v56, v226
    v_add_f32 v56, v56, v227
    v_add_f32 v56, v56, v228
    v_add_f32 v56, v56, v229
    v_add_f32 v56, v56, v230
    v_add_f32 v56, v56, v231
    s_nop 1
    v_add_f32_dpp v56, v56, v56 row_ror:8 row_mask:0xf bank_mask:0xf
    s_nop 1
    v_add_f32_dpp v56, v56, v56 row_ror:4 row_mask:0xf bank_mask:0xf
    s_nop 1
    v_add_f32_dpp v56, v56, v56 row_ror:2 row_mask:0xf bank_mask:0xf
    s_nop 1
    v_add_f32_dpp v56, v56, v56 row_ror:1 row_mask:0xf bank_mask:0xf
    v_mov_b32 v57, v56
    s_nop 1
    v_permlane16_swap_b32 v56, v57
    v_add_f32 v56, v56, v57
    v_mov_b32 v57, v56
    s_nop 1
    v_permlane32_swap_b32 v56, v57
    v_add_f32 v56, v56, v57
    v_mul_f32 v56, 0x3ae38e39, v56
    v_mov_b32 v57, 0
    v_sub_f32 v58, v220, v56
    v_fmac_f32 v57, v58, v58
    v_sub_f32 v58, v221, v56
    v_fmac_f32 v57, v58, v58
    v_sub_f32 v58, v222, v56
    v_fmac_f32 v57, v58, v58
    v_sub_f32 v58, v223, v56
    v_fmac_f32 v57, v58, v58
    v_sub_f32 v58, v224, v56
    v_fmac_f32 v57, v58, v58
    v_sub_f32 v58, v225, v56
    v_fmac_f32 v57, v58, v58
    v_sub_f32 v58, v226, v56
    v_fmac_f32 v57, v58, v58
    v_sub_f32 v58, v227, v56
    v_fmac_f32 v57, v58, v58
    s_mov_b64 exec, 0xffff
    v_sub_f32 v58, v228, v56
    v_fmac_f32 v57, v58, v58
    v_sub_f32 v58, v229, v56
    v_fmac_f32 v57, v58, v58
    v_sub_f32 v58, v230, v56
    v_fmac_f32 v57, v58, v58
    v_sub_f32 v58, v231, v56
    v_fmac_f32 v57, v58, v58
    s_mov_b64 exec, -1
    s_nop 0
    v_add_f32_dpp v57, v57, v57 row_ror:8 row_mask:0xf bank_mask:0xf
    s_nop 1
    v_add_f32_dpp v57, v57, v57 row_ror:4 row_mask:0xf bank_mask:0xf
    s_nop 1
    v_add_f32_dpp v57, v57, v57 row_ror:2 row_mask:0xf bank_mask:0xf
    s_nop 1
    v_add_f32_dpp v57, v57, v57 row_ror:1 row_mask:0xf bank_mask:0xf
    v_mov_b32 v58, v57
    s_nop 1
    v_permlane16_swap_b32 v57, v58
    v_add_f32 v57, v57, v58
    v_mov_b32 v58, v57
    s_nop 1
    v_permlane32_swap_b32 v57, v58
    v_add_f32 v57, v57, v58
    v_mul_f32 v57, 0x3ae38e39, v57
    v_cvt_pk_bf16_f32 v56, 0, v56
    v_cvt_pk_bf16_f32 v57, 0, v57
    v_add_f32 v57, 0x3727c5ac, v57
    v_cvt_pk_bf16_f32 v57, 0, v57
    v_sqrt_f32 v57, v57
    s_nop 0
    v_cvt_pk_bf16_f32 v57, 0, v57
    v_rcp_f32 v57, v57
    v_lshlrev_b32 v232, 16, v214
    v_and_b32 v233, 0xffff0000, v214
    v_lshlrev_b32 v234, 16, v215
    v_and_b32 v235, 0xffff0000, v215
    v_sub_f32 v232, v232, v56
    v_sub_f32 v233, v233, v56
    v_sub_f32 v234, v234, v56
    v_sub_f32 v235, v235, v56
    v_cvt_pk_bf16_f32 v232, 0, v232
    v_cvt_pk_bf16_f32 v233, 0, v233
    v_cvt_pk_bf16_f32 v234, 0, v234
    v_cvt_pk_bf16_f32 v235, 0, v235
    v_mul_f32 v232, v232, v57
    v_mul_f32 v233, v233, v57
    v_mul_f32 v234, v234, v57
    v_mul_f32 v235, v235, v57
    v_cvt_pk_bf16_f32 v232, 0, v232
    v_cvt_pk_bf16_f32 v233, 0, v233
    v_cvt_pk_bf16_f32 v234, 0, v234
    v_cvt_pk_bf16_f32 v235, 0, v235
    v_min_u32 v58, 7, v0
    v_lshlrev_b32 v58, 4, v58
    v_add_u32 v58, 1024, v58
    s_lshr_b32 s96, s88, 2
    s_mul_i32 s96, s96, 1152
    s_add_u32 s92, s96, 4096
    s_add_u32 s93, s92, 27648
    s_add_u32 s94, s92, 55296
    s_add_u32 s95, s92, 82944
    s_add_u32 s96, s92, 4608
    s_add_u32 s97, s93, 4608
    s_add_u32 s98, s94, 4608
    s_add_u32 s99, s95, 4608
    v_and_b32 v59, 3, v0
    v_mul_u32_u24 v59, 160, v59
    v_lshrrev_b32 v57, 2, v0
    v_lshl_add_u32 v59, v57, 2, v59
    s_cmp_eq_u32 s88, 0
    s_cbranch_scc0 L_sv_noinit
    s_mul_i32 s30, s87, 256
    s_add_u32 s30, s30, 786432
    v_mov_b32 v56, 65536
    v_mov_b32 v57, 0
    s_mov_b64 exec, 1
    buffer_store_dword v56, v57, s[40:43], s30 offen sc1
    s_mov_b64 exec, -1
L_sv_noinit:
    s_mov_b32 s83, 50000
L_p1poll:
    buffer_load_dwordx4 v[64:67], v8, s[40:43], s92 offen sc1
    buffer_load_dwordx4 v[72:75], v8, s[40:43], s96 offen sc1
    buffer_load_dwordx4 v[80:83], v8, s[40:43], s93 offen sc1
    buffer_load_dwordx4 v[88:91], v8, s[40:43], s97 offen sc1
    buffer_load_dwordx4 v[96:99], v8, s[40:43], s94 offen sc1
    buffer_load_dwordx4 v[104:107], v8, s[40:43], s98 offen sc1
    buffer_load_dwordx4 v[112:115], v8, s[40:43], s95 offen sc1
    buffer_load_dwordx4 v[120:123], v8, s[40:43], s99 offen sc1
    buffer_load_dwordx4 v[68:71], v58, s[40:43], s92 offen sc1
    buffer_load_dwordx4 v[76:79], v58, s[40:43], s96 offen sc1
    buffer_load_dwordx4 v[84:87], v58, s[40:43], s93 offen sc1
    buffer_load_dwordx4 v[92:95], v58, s[40:43], s97 offen sc1
    buffer_load_dwordx4 v[100:103], v58, s[40:43], s94 offen sc1
    buffer_load_dwordx4 v[108:111], v58, s[40:43], s98 offen sc1
    buffer_load_dwordx4 v[116:119], v58, s[40:43], s95 offen sc1
    buffer_load_dwordx4 v[124:127], v58, s[40:43], s99 offen sc1
    s_waitcnt vmcnt(0)
    v_max_u32 v56, v65, v67
    v_min_u32 v57, v65, v67
    v_max3_u32 v56, v56, v69, v71
    v_min3_u32 v57, v57, v69, v71
    v_max3_u32 v56, v56, v73, v75
    v_min3_u32 v57, v57, v73, v75
    v_max3_u32 v56, v56, v77, v79
    v_min3_u32 v57, v57, v77, v79
    v_max3_u32 v56, v56, v81, v83
    v_min3_u32 v57, v57, v81, v83
    v_max3_u32 v56, v56, v85, v87
    v_min3_u32 v57, v57, v85, v87
    v_max3_u32 v56, v56, v89, v91
    v_min3_u32 v57, v57, v89, v91
    v_max3_u32 v56, v56, v93, v95
    v_min3_u32 v57, v57, v93, v95
    v_max3_u32 v56, v56, v97, v99
    v_min3_u32 v57, v57, v97, v99
    v_max3_u32 v56, v56, v101, v103
    v_min3_u32 v57, v57, v101, v103
    v_max3_u32 v56, v56, v105, v107
    v_min3_u32 v57, v57, v105, v107
    v_max3_u32 v56, v56, v109, v111
    v_min3_u32 v57, v57, v109, v111
    v_max3_u32 v56, v56, v113, v115
    v_min3_u32 v57, v57, v113, v115
    v_max3_u32 v56, v56, v117, v119
    v_min3_u32 v57, v57, v117, v119
    v_max3_u32 v56, v56, v121, v123
    v_min3_u32 v57, v57, v121, v123
    v_max3_u32 v56, v56, v125, v127
    v_min3_u32 v57, v57, v125, v127
    v_xor_b32 v56, s80, v56
    v_xor_b32 v57, s80, v57
    v_or_b32 v56, v56, v57
    v_cmp_ne_u32 vcc, 0, v56
    s_cbranch_vccz L_p1poll_ok
    s_sub_u32 s83, s83, 1
    s_cmp_lg_u32 s83, 0
    s_nop 1
    s_cbranch_scc1 L_p1poll
L_p1poll_ok:
    v_add_f32 v64, v64, v80
    v_add_f32 v96, v96, v112
    v_add_f32 v66, v66, v82
    v_add_f32 v98, v98, v114
    v_add_f32 v68, v68, v84
    v_add_f32 v100, v100, v116
    v_add_f32 v70, v70, v86
    v_add_f32 v102, v102, v118
    v_add_f32 v72, v72, v88
    v_add_f32 v104, v104, v120
    v_add_f32 v74, v74, v90
    v_add_f32 v106, v106, v122
    v_add_f32 v76, v76, v92
    v_add_f32 v108, v108, v124
    v_add_f32 v78, v78, v94
    v_add_f32 v110, v110, v126
    v_add_f32 v64, v64, v96
    v_add_f32 v66, v66, v98
    v_add_f32 v68, v68, v100
    v_add_f32 v70, v70, v102
    v_add_f32 v72, v72, v104
    v_add_f32 v74, v74, v106
    v_add_f32 v76, v76, v108
    v_add_f32 v78, v78, v110
    v_cvt_pk_bf16_f32 v64, 0, v64
    v_cvt_pk_bf16_f32 v66, 0, v66
    v_cvt_pk_bf16_f32 v68, 0, v68
    v_cvt_pk_bf16_f32 v70, 0, v70
    v_cvt_pk_bf16_f32 v72, 0, v72
    v_cvt_pk_bf16_f32 v74, 0, v74
    v_cvt_pk_bf16_f32 v76, 0, v76
    v_cvt_pk_bf16_f32 v78, 0, v78
    v_add_f32 v72, 1.0, v72
    v_add_f32 v74, 1.0, v74
    v_add_f32 v76, 1.0, v76
    v_add_f32 v78, 1.0, v78
    v_cvt_pk_bf16_f32 v72, 0, v72
    v_cvt_pk_bf16_f32 v74, 0, v74
    v_cvt_pk_bf16_f32 v76, 0, v76
    v_cvt_pk_bf16_f32 v78, 0, v78
    v_mul_f32 v72, v72, v232
    v_mul_f32 v74, v74, v233
    v_mul_f32 v76, v76, v234
    v_mul_f32 v78, v78, v235
    v_cvt_pk_bf16_f32 v72, 0, v72
    v_cvt_pk_bf16_f32 v74, 0, v74
    v_cvt_pk_bf16_f32 v76, 0, v76
    v_cvt_pk_bf16_f32 v78, 0, v78
    v_add_f32 v72, v72, v64
    v_add_f32 v74, v74, v66
    v_add_f32 v76, v76, v68
    v_add_f32 v78, v78, v70
    v_cvt_pk_bf16_f32 v72, v72, v72
    v_cvt_pk_bf16_f32 v74, v74, v74
    v_cvt_pk_bf16_f32 v76, v76, v76
    v_cvt_pk_bf16_f32 v78, v78, v78
    v_add_u32 v59, 3328, v59
    ds_write2_b32 v59, v72, v74 offset0:0 offset1:20
    s_mov_b64 exec, 0xff
    ds_write2_b32 v59, v76, v78 offset0:16 offset1:36
    s_mov_b64 exec, -1
    s_waitcnt lgkmcnt(0)
    ds_read_b128 v[16:19], v13 offset:3328
    ds_read_b128 v[20:23], v13 offset:3344
    ds_read_b128 v[24:27], v13 offset:3360
    ds_read_b128 v[28:31], v13 offset:3376
    ds_read_b128 v[32:35], v13 offset:3392
    s_lshl_b32 s92, s87, 2
    s_lshr_b32 s93, s88, 2
    s_add_u32 s92, s92, s93
    s_lshl_b32 s92, s92, 11
    s_and_b32 s93, s88, 3
    s_lshl_b32 s93, s93, 9
    s_add_u32 s92, s92, s93
    s_add_u32 s92, s92, 196608
    s_lshl_b32 s93, s87, 13
    s_add_u32 s93, s93, 196608
    s_add_u32 s94, s93, 2048
    s_add_u32 s95, s93, 4096
    s_add_u32 s96, s93, 6144
    s_waitcnt lgkmcnt(0)
    v_and_b32 v40, v16, v4
    v_and_b32 v41, v16, v5
    v_and_b32 v42, v16, v6
    v_and_b32 v43, v16, v7
    v_and_b32 v44, v17, v4
    v_and_b32 v45, v17, v5
    v_and_b32 v46, v17, v6
    v_and_b32 v47, v17, v7
    v_mfma_f32_16x16x32_bf16 v[48:51], v[40:43], v[136:139], 0
    v_and_b32 v40, v18, v4
    v_and_b32 v41, v18, v5
    v_and_b32 v42, v18, v6
    v_and_b32 v43, v18, v7
    v_mfma_f32_16x16x32_bf16 v[48:51], v[44:47], v[140:143], v[48:51]
    v_and_b32 v44, v19, v4
    v_and_b32 v45, v19, v5
    v_and_b32 v46, v19, v6
    v_and_b32 v47, v19, v7
    v_mfma_f32_16x16x32_bf16 v[48:51], v[40:43], v[144:147], v[48:51]
    v_and_b32 v40, v20, v4
    v_and_b32 v41, v20, v5
    v_and_b32 v42, v20, v6
    v_and_b32 v43, v20, v7
    v_mfma_f32_16x16x32_bf16 v[48:51], v[44:47], v[148:151], v[48:51]
    v_and_b32 v44, v21, v4
    v_and_b32 v45, v21, v5
    v_and_b32 v46, v21, v6
    v_and_b32 v47, v21, v7
    v_mfma_f32_16x16x32_bf16 v[48:51], v[40:43], v[152:155], v[48:51]
    v_and_b32 v40, v22, v4
    v_and_b32 v41, v22, v5
    v_and_b32 v42, v22, v6
    v_and_b32 v43, v22, v7
    v_mfma_f32_16x16x32_bf16 v[48:51], v[44:47], v[156:159], v[48:51]
    v_and_b32 v44, v23, v4
    v_and_b32 v45, v23, v5
    v_and_b32 v46, v23, v6
    v_and_b32 v47, v23, v7
    v_mfma_f32_16x16x32_bf16 v[48:51], v[40:43], v[160:163], v[48:51]
    v_and_b32 v40, v24, v4
    v_and_b32 v41, v24, v5
    v_and_b32 v42, v24, v6
    v_and_b32 v43, v24, v7
    v_mfma_f32_16x16x32_bf16 v[48:51], v[44:47], v[164:167], v[48:51]
    v_and_b32 v44, v25, v4
    v_and_b32 v45, v25, v5
    v_and_b32 v46, v25, v6
    v_and_b32 v47, v25, v7
    v_mfma_f32_16x16x32_bf16 v[48:51], v[40:43], v[168:171], v[48:51]
    v_and_b32 v40, v26, v4
    v_and_b32 v41, v26, v5
    v_and_b32 v42, v26, v6
    v_and_b32 v43, v26, v7
    v_mfma_f32_16x16x32_bf16 v[48:51], v[44:47], v[172:175], v[48:51]
    v_and_b32 v44, v27, v4
    v_and_b32 v45, v27, v5
    v_and_b32 v46, v27, v6
    v_and_b32 v47, v27, v7
    v_mfma_f32_16x16x32_bf16 v[48:51], v[40:43], v[176:179], v[48:51]
    v_and_b32 v40, v28, v4
    v_and_b32 v41, v28, v5
    v_and_b32 v42, v28, v6
    v_and_b32 v43, v28, v7
    v_mfma_f32_16x16x32_bf16 v[48:51], v[44:47], v[180:183], v[48:51]
    v_and_b32 v44, v29, v4
    v_and_b32 v45, v29, v5
    v_and_b32 v46, v29, v6
    v_and_b32 v47, v29, v7
    v_mfma_f32_16x16x32_bf16 v[48:51], v[40:43], v[184:187], v[48:51]
    v_and_b32 v40, v30, v4
    v_and_b32 v41, v30, v5
    v_and_b32 v42, v30, v6
    v_and_b32 v43, v30, v7
    v_mfma_f32_16x16x32_bf16 v[48:51], v[44:47], v[188:191], v[48:51]
    v_and_b32 v44, v31, v4
    v_and_b32 v45, v31, v5
    v_and_b32 v46, v31, v6
    v_and_b32 v47, v31, v7
    v_mfma_f32_16x16x32_bf16 v[48:51], v[40:43], v[192:195], v[48:51]
    v_and_b32 v40, v32, v4
    v_and_b32 v41, v32, v5
    v_and_b32 v42, v32, v6
    v_and_b32 v43, v32, v7
    v_mfma_f32_16x16x32_bf16 v[48:51], v[44:47], v[196:199], v[48:51]
    v_and_b32 v44, v33, v4
    v_and_b32 v45, v33, v5
    v_and_b32 v46, v33, v6
    v_and_b32 v47, v33, v7
    v_mfma_f32_16x16x32_bf16 v[48:51], v[40:43], v[200:203], v[48:51]
    s_nop 0
    v_mfma_f32_16x16x32_bf16 v[48:51], v[44:47], v[204:207], v[48:51]
    s_nop 7
    v_mov_b32 v52, v48
    v_mov_b32 v53, v49
    v_mov_b32 v54, v50
    v_mov_b32 v55, v51
    v_permlane32_swap_b32 v48, v52
    v_permlane32_swap_b32 v49, v53
    v_permlane32_swap_b32 v50, v54
    v_permlane32_swap_b32 v51, v55
    v_add_f32_dpp v48, v52, v48 row_ror:8 row_mask:0xf bank_mask:0xf
    v_add_f32_dpp v49, v53, v49 row_ror:8 row_mask:0xf bank_mask:0xf
    v_add_f32_dpp v50, v54, v50 row_ror:8 row_mask:0xf bank_mask:0xf
    v_add_f32_dpp v51, v55, v51 row_ror:8 row_mask:0xf bank_mask:0xf
    v_mov_b32 v240, v48
    v_mov_b32 v241, s80
    v_mov_b32 v242, v49
    v_mov_b32 v243, s80
    v_mov_b32 v244, v50
    v_mov_b32 v245, s80
    v_mov_b32 v246, v51
    v_mov_b32 v247, s80
    s_mov_b32 s30, 0x00ff00ff
    s_mov_b32 s31, 0
    s_mov_b64 exec, s[30:31]
    buffer_store_dwordx4 v[240:243], v15, s[40:43], s92 offen sc1
    buffer_store_dwordx4 v[244:247], v15, s[40:43], s92 offen offset:16 sc1
    s_mov_b64 exec, -1
    s_mov_b32 s83, 50000
L_p2poll:
    buffer_load_dwordx4 v[64:67], v8, s[40:43], s93 offen offset:0 sc1
    buffer_load_dwordx4 v[68:71], v8, s[40:43], s93 offen offset:1024 sc1
    buffer_load_dwordx4 v[72:75], v8, s[40:43], s94 offen offset:0 sc1
    buffer_load_dwordx4 v[76:79], v8, s[40:43], s94 offen offset:1024 sc1
    buffer_load_dwordx4 v[80:83], v8, s[40:43], s95 offen offset:0 sc1
    buffer_load_dwordx4 v[84:87], v8, s[40:43], s95 offen offset:1024 sc1
    buffer_load_dwordx4 v[88:91], v8, s[40:43], s96 offen offset:0 sc1
    buffer_load_dwordx4 v[92:95], v8, s[40:43], s96 offen offset:1024 sc1
    s_waitcnt vmcnt(0)
    v_max_u32 v56, v65, v67
    v_min_u32 v57, v65, v67
    v_max3_u32 v56, v56, v69, v71
    v_min3_u32 v57, v57, v69, v71
    v_max3_u32 v56, v56, v73, v75
    v_min3_u32 v57, v57, v73, v75
    v_max3_u32 v56, v56, v77, v79
    v_min3_u32 v57, v57, v77, v79
    v_max3_u32 v56, v56, v81, v83
    v_min3_u32 v57, v57, v81, v83
    v_max3_u32 v56, v56, v85, v87
    v_min3_u32 v57, v57, v85, v87
    v_max3_u32 v56, v56, v89, v91
    v_min3_u32 v57, v57, v89, v91
    v_max3_u32 v56, v56, v93, v95
    v_min3_u32 v57, v57, v93, v95
    v_xor_b32 v56, s80, v56
    v_xor_b32 v57, s80, v57
    v_or_b32 v56, v56, v57
    v_cmp_ne_u32 vcc, 0, v56
    s_cbranch_vccz L_p2poll_ok
    s_sub_u32 s83, s83, 1
    s_cmp_lg_u32 s83, 0
    s_nop 1
    s_cbranch_scc1 L_p2poll
L_p2poll_ok:
    v_add_f32 v64, v64, v72
    v_add_f32 v80, v80, v88
    v_add_f32 v66, v66, v74
    v_add_f32 v82, v82, v90
    v_add_f32 v68, v68, v76
    v_add_f32 v84, v84, v92
    v_add_f32 v70, v70, v78
    v_add_f32 v86, v86, v94
    v_add_f32 v64, v64, v80
    v_add_f32 v66, v66, v82
    v_add_f32 v68, v68, v84
    v_add_f32 v70, v70, v86
    v_cvt_pk_bf16_f32 v64, v64, v66
    v_cvt_pk_bf16_f32 v68, v68, v70
    ds_write_b32 v2, v64 offset:0
    ds_write_b32 v2, v68 offset:256
    s_waitcnt lgkmcnt(0)
    v_mov_b32 v56, 0
    v_mov_b32 v57, 1
    ds_write_b32 v56, v57 offset:2604
    s_setprio 1
    s_cmp_eq_u32 s89, 0
    s_cbranch_scc0 L_sv_now
    s_mov_b32 s68, s18
    s_and_b32 s69, s19, 0xffff
    s_mov_b32 s70, 5308416
    s_mov_b32 s71, 0x20000
    s_mov_b32 s72, s20
    s_and_b32 s73, s21, 0xffff
    s_mov_b32 s74, 5308416
    s_mov_b32 s75, 0x20000
    v_mul_u32_u24 v56, 9216, v9
    v_add_u32 v56, v56, v10
    v_mul_u32_u24 v57, 1152, v9
    v_add_u32 v57, v57, v10
    s_lshl_b32 s92, s90, 7
    s_add_u32 s92, s92, 3981312
    s_setprio 0
    buffer_load_dwordx4 v[64:67], v56, s[68:71], s92 offen nt
    s_add_u32 s92, s92, 73728
    buffer_load_dwordx4 v[68:71], v56, s[68:71], s92 offen nt
    s_add_u32 s92, s92, 73728
    buffer_load_dwordx4 v[72:75], v56, s[68:71], s92 offen nt
    s_add_u32 s92, s92, 73728
    buffer_load_dwordx4 v[76:79], v56, s[68:71], s92 offen nt
    s_add_u32 s92, s92, 73728
    buffer_load_dwordx4 v[96:99], v56, s[68:71], s92 offen nt
    s_add_u32 s92, s92, 73728
    buffer_load_dwordx4 v[100:103], v56, s[68:71], s92 offen nt
    s_add_u32 s92, s92, 73728
    buffer_load_dwordx4 v[104:107], v56, s[68:71], s92 offen nt
    s_add_u32 s92, s92, 73728
    buffer_load_dwordx4 v[108:111], v56, s[68:71], s92 offen nt
    s_add_u32 s92, s92, 73728
    buffer_load_dwordx4 v[128:131], v56, s[68:71], s92 offen nt
    s_add_u32 s92, s92, 73728
    buffer_load_dwordx4 v[132:135], v56, s[68:71], s92 offen nt
    s_add_u32 s92, s92, 73728
    buffer_load_dwordx4 v[136:139], v56, s[68:71], s92 offen nt
    s_add_u32 s92, s92, 73728
    buffer_load_dwordx4 v[140:143], v56, s[68:71], s92 offen nt
    s_add_u32 s92, s92, 73728
    buffer_load_dwordx4 v[160:163], v56, s[68:71], s92 offen nt
    s_add_u32 s92, s92, 73728
    buffer_load_dwordx4 v[164:167], v56, s[68:71], s92 offen nt
    s_add_u32 s92, s92, 73728
    buffer_load_dwordx4 v[168:171], v56, s[68:71], s92 offen nt
    s_add_u32 s92, s92, 73728
    buffer_load_dwordx4 v[172:175], v56, s[68:71], s92 offen nt
    s_add_u32 s92, s92, 73728
    buffer_load_dwordx4 v[192:195], v56, s[68:71], s92 offen nt
    s_add_u32 s92, s92, 73728
    buffer_load_dwordx4 v[196:199], v56, s[68:71], s92 offen nt
    s_mul_i32 s92, s90, 73728
    s_add_u32 s92, s92, 896
    s_add_u32 s93, s92, 128
    buffer_load_dwordx4 v[200:203], v57, s[72:75], s92 offen nt
    buffer_load_dwordx4 v[228:231], v57, s[72:75], s93 offen nt
    s_add_u32 s92, s92, 9216
    s_add_u32 s93, s93, 9216
    buffer_load_dwordx4 v[204:207], v57, s[72:75], s92 offen nt
    buffer_load_dwordx4 v[116:119], v57, s[72:75], s93 offen nt
    s_add_u32 s92, s92, 9216
    s_add_u32 s93, s93, 9216
    buffer_load_dwordx4 v[80:83], v57, s[72:75], s92 offen nt
    buffer_load_dwordx4 v[148:151], v57, s[72:75], s93 offen nt
    s_add_u32 s92, s92, 9216
    s_add_u32 s93, s93, 9216
    buffer_load_dwordx4 v[112:115], v57, s[72:75], s92 offen nt
    buffer_load_dwordx4 v[180:183], v57, s[72:75], s93 offen nt
    s_add_u32 s92, s92, 9216
    s_add_u32 s93, s93, 9216
    buffer_load_dwordx4 v[144:147], v57, s[72:75], s92 offen nt
    buffer_load_dwordx4 v[212:215], v57, s[72:75], s93 offen nt
    s_add_u32 s92, s92, 9216
    s_add_u32 s93, s93, 9216
    buffer_load_dwordx4 v[176:179], v57, s[72:75], s92 offen nt
    buffer_load_dwordx4 v[244:247], v57, s[72:75], s93 offen nt
    s_add_u32 s92, s92, 9216
    s_add_u32 s93, s93, 9216
    buffer_load_dwordx4 v[208:211], v57, s[72:75], s92 offen nt
    buffer_load_dwordx4 v[88:91], v57, s[72:75], s93 offen nt
    s_add_u32 s92, s92, 9216
    s_add_u32 s93, s93, 9216
    buffer_load_dwordx4 v[84:87], v57, s[72:75], s92 offen nt
    buffer_load_dwordx4 v[120:123], v57, s[72:75], s93 offen nt
    s_setprio 1
L_sv_now:
    v_mov_b32 v44, -1
    v_mov_b32 v45, -1
    v_mov_b32 v46, -1
    v_mov_b32 v47, -1
    s_lshl_b32 s30, s2, 10
    s_add_u32 s30, s30, 327680
    buffer_store_dwordx4 v[44:47], v8, s[40:43], s30 offen sc1
    s_mov_b64 exec, 1
    s_lshl_b32 s30, s2, 4
    s_add_u32 s30, s30, 126976
    buffer_store_dwordx4 v[44:47], v8, s[40:43], s30 offen sc1
    s_mov_b64 exec, -1
    s_cmp_eq_u32 s89, 1
    s_cbranch_scc1 L_sv_clr_done
    s_cmp_eq_u32 s89, 0
    s_cbranch_scc1 L_sv_clr_ffn
    s_mul_i32 s30, s87, 2304
    s_lshl_b32 s92, s90, 8
    s_add_u32 s30, s30, s92
    s_add_u32 s30, s30, 131072
    s_mov_b64 exec, 0xffff
    buffer_store_dwordx4 v[44:47], v8, s[40:43], s30 offen sc1
    s_mov_b64 exec, -1
    s_branch L_sv_clr_done
L_sv_clr_ffn:
    s_mul_i32 s30, s90, 2304
    s_add_u32 s30, s30, 589824
    buffer_store_dwordx4 v[44:47], v8, s[40:43], s30 offen sc1
    buffer_store_dwordx4 v[44:47], v8, s[40:43], s30 offen offset:1024 sc1
    s_mov_b64 exec, 0xffff
    buffer_store_dwordx4 v[44:47], v8, s[40:43], s30 offen offset:2048 sc1
    s_mov_b64 exec, -1
    s_nop 0
L_sv_clr_done:
    s_waitcnt vmcnt(0)
    v_mov_b32 v44, s80
    s_lshl_b32 s30, s2, 2
    s_add_u32 s30, s30, 1024
    v_mov_b32 v45, 0
    s_mov_b64 exec, 1
    buffer_store_dword v44, v45, s[40:43], s30 offen sc1
    s_mov_b64 exec, -1
    s_mov_b32 s72, s20
    s_and_b32 s73, s21, 0xffff
    s_mov_b32 s74, 5308416
    s_mov_b32 s75, 0x20000
    s_mov_b32 s76, s26
    s_and_b32 s77, s27, 0xffff
    s_mov_b32 s78, 1152
    s_mov_b32 s79, 0x20000
    s_cmp_lg_u32 s89, 1
    s_cbranch_scc1 L_broker
    s_cmp_lt_u32 s90, 36
    s_cbranch_scc0 L_broker
    v_and_b32 v56, 31, v0
    v_lshlrev_b32 v57, 3, v56
    v_lshlrev_b32 v56, 4, v56
    s_lshl_b32 s92, s90, 9
    s_add_u32 s92, s92, 13312
    s_add_u32 s93, s92, 27648
    s_add_u32 s94, s92, 55296
    s_add_u32 s95, s92, 82944
    s_mov_b32 s83, 50000
L_p3bpoll:
    buffer_load_dwordx4 v[64:67], v56, s[40:43], s92 offen sc1
    buffer_load_dwordx4 v[68:71], v56, s[40:43], s93 offen sc1
    buffer_load_dwordx4 v[72:75], v56, s[40:43], s94 offen sc1
    buffer_load_dwordx4 v[76:79], v56, s[40:43], s95 offen sc1
    s_waitcnt vmcnt(0)
    v_max_u32 v58, v65, v67
    v_min_u32 v59, v65, v67
    v_max3_u32 v58, v58, v69, v71
    v_min3_u32 v59, v59, v69, v71
    v_max3_u32 v58, v58, v73, v75
    v_min3_u32 v59, v59, v73, v75
    v_max3_u32 v58, v58, v77, v79
    v_min3_u32 v59, v59, v77, v79
    v_xor_b32 v58, s80, v58
    v_xor_b32 v59, s80, v59
    v_or_b32 v58, v58, v59
    v_cmp_ne_u32 vcc, 0, v58
    s_cbranch_vccz L_p3bpoll_ok
    s_sub_u32 s83, s83, 1
    s_cmp_lg_u32 s83, 0
    s_nop 1
    s_cbranch_scc1 L_p3bpoll
L_p3bpoll_ok:
    v_add_f32 v64, v64, v68
    v_add_f32 v72, v72, v76
    v_add_f32 v66, v66, v70
    v_add_f32 v74, v74, v78
    v_add_f32 v64, v64, v72
    v_add_f32 v66, v66, v74
    v_cvt_pk_bf16_f32 v64, v64, v66
    v_mov_b32 v65, s80
    s_lshl_b32 s30, s90, 8
    s_add_u32 s30, s30, 114688
    s_mov_b64 exec, 0xffffffff
    buffer_store_dwordx2 v[64:65], v57, s[40:43], s30 offen sc1
    s_mov_b64 exec, -1
    s_branch L_broker
L_broker:
    s_mul_i32 s51, s87, 256
    s_add_u32 s51, s51, 786432
    v_mov_b32 v57, 0
    v_mov_b32 v16, 2
    s_mov_b32 s48, 96
    s_mov_b32 s49, 0
    s_mov_b32 s53, 0
    s_mov_b32 s54, 0
    s_mov_b32 s52, 512
    s_cmp_eq_u32 s89, 0
    s_cselect_b32 s52, 200, s52
    s_cbranch_scc0 L_bk_nq3
    s_and_b32 s92, s90, 7
    s_cmp_eq_u32 s92, 3
    s_cselect_b32 s52, 200, s52
L_bk_nq3:
    s_waitcnt vmcnt(0)
    s_mov_b32 s83, 400000
    s_mov_b32 s52, 512
    s_mov_b32 s55, 0
    s_cmp_eq_u32 s88, 15
    s_cselect_b32 s52, 512, s52
    s_cmp_eq_u32 s89, 0
    s_cbranch_scc0 L_bk_qa
    s_mov_b32 s52, 350
    s_mov_b32 s55, 4
    s_and_b32 s92, s90, 7
    s_cmp_eq_u32 s92, 3
    s_cselect_b32 s52, 230, s52
L_bk_qa:
L_bk_loop:
    ds_read_b32 v58, v57 offset:2592
    v_cmp_le_u32 vcc, 65536, v16
    s_cmp_lt_u32 s54, s53
    s_cbranch_scc0 L_bk_nofill
    s_bitcmp1_b64 vcc, s54
    s_cbranch_scc0 L_bk_nofill
    v_readlane_b32 s92, v16, s54
    s_sub_u32 s92, s92, 65536
    s_min_u32 s92, s92, 512
    s_sub_u32 s93, 512, s92
    s_min_u32 s93, s93, 2
    v_add_u32 v59, s92, v0
    v_bfe_u32 v60, v59, 5, 4
    v_lshlrev_b32 v60, 19, v60
    v_lshrrev_b32 v61, 9, v59
    v_lshlrev_b32 v61, 5, v61
    v_and_or_b32 v61, v59, 31, v61
    v_add_u32 v61, 96, v61
    v_lshl_add_u32 v60, v61, 12, v60
    v_or_b32 v60, 1, v60
    v_cmp_le_u32 vcc, 460, v59
    s_nop 1
    v_cndmask_b32 v61, 0, 2, vcc
    v_or_b32 v60, v60, v61
    s_lshl_b32 s94, s49, 2
    v_add_u32 v59, s94, v2
    v_cmp_gt_u32 vcc, s93, v0
    s_and_b64 exec, vcc, -1
    ds_write_b32 v59, v60 offset:49152
    s_mov_b64 exec, -1
    s_add_u32 s49, s49, s93
    s_mul_i32 s94, s93, s55
    s_add_u32 s52, s52, s94
    s_min_u32 s52, s52, 512
    s_add_u32 s54, s54, 1
    s_add_u32 s92, s92, 2
    s_cmp_ge_u32 s92, s52
    s_cbranch_scc1 L_bk_drain
L_bk_nofill:
    s_waitcnt lgkmcnt(0)
    v_readfirstlane_b32 s50, v58
    s_cmp_gt_u32 s50, s48
    s_cbranch_scc0 L_bk_noreq
    s_cmp_lt_u32 s53, 64
    s_cbranch_scc0 L_bk_wrap
    s_lshl_b64 exec, 1, s53
    buffer_atomic_add v16, v57, s[40:43], s51 offen sc0
    s_mov_b64 exec, -1
    s_add_u32 s48, s48, 2
    s_add_u32 s53, s53, 1
L_bk_noreq:
    s_sub_u32 s83, s83, 1
    s_cmp_lg_u32 s83, 0
    s_cbranch_scc1 L_bk_loop
    s_branch L_bk_drain
L_bk_wrap:
    s_cmp_eq_u32 s54, 64
    s_cbranch_scc0 L_bk_noreq
    v_mov_b32 v16, 2
    s_mov_b32 s53, 0
    s_mov_b32 s54, 0
    s_branch L_bk_noreq
L_bk_drain:
    s_waitcnt vmcnt(0) lgkmcnt(0)
L_bk_dl:
    s_cmp_ge_u32 s54, s53
    s_cbranch_scc1 L_bk_dd
    v_readlane_b32 s92, v16, s54
    s_sub_u32 s92, s92, 65536
    s_min_u32 s92, s92, 512
    s_sub_u32 s93, 512, s92
    s_min_u32 s93, s93, 2
    v_add_u32 v59, s92, v0
    v_bfe_u32 v60, v59, 5, 4
    v_lshlrev_b32 v60, 19, v60
    v_lshrrev_b32 v61, 9, v59
    v_lshlrev_b32 v61, 5, v61
    v_and_or_b32 v61, v59, 31, v61
    v_add_u32 v61, 96, v61
    v_lshl_add_u32 v60, v61, 12, v60
    v_or_b32 v60, 1, v60
    v_cmp_le_u32 vcc, 460, v59
    s_nop 1
    v_cndmask_b32 v61, 0, 2, vcc
    v_or_b32 v60, v60, v61
    s_lshl_b32 s94, s49, 2
    v_add_u32 v59, s94, v2
    v_cmp_gt_u32 vcc, s93, v0
    s_and_b64 exec, vcc, -1
    ds_write_b32 v59, v60 offset:49152
    s_mov_b64 exec, -1
    s_add_u32 s49, s49, s93
    s_mul_i32 s94, s93, s55
    s_add_u32 s52, s52, s94
    s_min_u32 s52, s52, 512
    s_add_u32 s54, s54, 1
    s_add_u32 s92, s92, 2
    s_cmp_ge_u32 s92, s52
    s_branch L_bk_dl
L_bk_dd:
    s_lshl_b32 s94, s49, 2
    v_add_u32 v59, s94, v2
    v_mov_b32 v60, 0x80000000
    ds_write_b32 v59, v60 offset:49152
    s_cmp_eq_u32 s89, 1
    s_cbranch_scc1 L_sv_b1
L_sv_hello:
    s_mov_b32 s30, 1024
    s_mov_b32 s83, 50000
L_hpoll:
    buffer_load_dwordx4 v[48:51], v8, s[40:43], s30 offen sc1
    s_waitcnt vmcnt(0)
    v_max_u32 v58, v48, v49
    v_min_u32 v59, v48, v49
    v_max3_u32 v58, v58, v50, v51
    v_min3_u32 v59, v59, v50, v51
    v_xor_b32 v58, s80, v58
    v_xor_b32 v59, s80, v59
    v_or_b32 v58, v58, v59
    v_cmp_ne_u32 vcc, 0, v58
    s_cbranch_vccz L_hpoll_ok
    s_sub_u32 s83, s83, 1
    s_cmp_lg_u32 s83, 0
    s_nop 1
    s_cbranch_scc1 L_hpoll
L_hpoll_ok:
    v_mov_b32 v58, 0
    v_mov_b32 v59, 1
    ds_write_b32 v58, v59 offset:2600
    s_nop 0
L_sv_b1:
    s_setprio 3
    v_lshrrev_b32 v1, 5, v0
    v_lshlrev_b32 v1, 5, v1
    s_lshl_b32 s92, s2, 10
    s_add_u32 s92, s92, 327680
    s_lshl_b32 s93, s2, 4
    s_add_u32 s93, s93, 126976
    v_lshrrev_b32 v2, 5, v0
    v_lshlrev_b32 v2, 3, v2
    v_mov_b32 v3, 0
    s_waitcnt vmcnt(0) lgkmcnt(0)
    s_cmp_eq_u32 s89, 0
    s_cbranch_scc1 L_ts_arr
    s_barrier
    s_branch L_ts_go
L_ts_arr:
    s_mov_b32 s83, 200000
L_arr:
    ds_read_b32 v9, v3 offset:2596
    s_waitcnt lgkmcnt(0)
    v_readfirstlane_b32 s30, v9
    s_cmp_eq_u32 s30, 7
    s_cbranch_scc1 L_arr_ok
    s_sub_u32 s83, s83, 1
    s_cmp_lg_u32 s83, 0
    s_nop 0
    s_cbranch_scc1 L_arr
L_arr_ok:
L_ts_go:
    ds_read_b128 v[16:19], v1 offset:2624
    ds_read_b128 v[20:23], v1 offset:2640
    ds_read_b128 v[24:27], v1 offset:2688
    ds_read_b128 v[28:31], v1 offset:2704
    ds_read_b128 v[92:95], v8 offset:9216
    ds_read_b128 v[124:127], v8 offset:10240
    ds_read_b128 v[156:159], v8 offset:11264
    ds_read_b128 v[188:191], v8 offset:12288
    ds_read_b128 v[220:223], v8 offset:13312
    ds_read_b128 v[252:255], v8 offset:14336
    ds_read_b128 v[232:235], v8 offset:15360
    s_waitcnt lgkmcnt(9)
    v_max3_f32 v32, v16, v17, v18
    v_max3_f32 v32, v32, v19, v20
    v_max3_f32 v32, v32, v21, v22
    v_sub_f32 v16, v16, v32
    v_sub_f32 v17, v17, v32
    v_sub_f32 v18, v18, v32
    v_sub_f32 v19, v19, v32
    v_sub_f32 v20, v20, v32
    v_sub_f32 v21, v21, v32
    v_sub_f32 v22, v22, v32
    v_exp_f32 v16, v16
    v_exp_f32 v17, v17
    v_exp_f32 v18, v18
    v_exp_f32 v19, v19
    v_exp_f32 v20, v20
    v_exp_f32 v21, v21
    v_exp_f32 v22, v22
    s_waitcnt lgkmcnt(7)
    v_mul_f32 v33, v16, v24
    v_fmac_f32 v33, v17, v25
    v_fmac_f32 v33, v18, v26
    v_fmac_f32 v33, v19, v27
    v_fmac_f32 v33, v20, v28
    v_fmac_f32 v33, v21, v29
    v_fmac_f32 v33, v22, v30
    s_waitcnt lgkmcnt(6)
    v_mul_f32 v36, v16, v92
    v_mul_f32 v37, v16, v93
    v_mul_f32 v38, v16, v94
    v_mul_f32 v39, v16, v95
    s_waitcnt lgkmcnt(5)
    v_fmac_f32 v36, v17, v124
    v_fmac_f32 v37, v17, v125
    v_fmac_f32 v38, v17, v126
    v_fmac_f32 v39, v17, v127
    s_waitcnt lgkmcnt(4)
    v_fmac_f32 v36, v18, v156
    v_fmac_f32 v37, v18, v157
    v_fmac_f32 v38, v18, v158
    v_fmac_f32 v39, v18, v159
    s_waitcnt lgkmcnt(3)
    v_fmac_f32 v36, v19, v188
    v_fmac_f32 v37, v19, v189
    v_fmac_f32 v38, v19, v190
    v_fmac_f32 v39, v19, v191
    s_waitcnt lgkmcnt(2)
    v_fmac_f32 v36, v20, v220
    v_fmac_f32 v37, v20, v221
    v_fmac_f32 v38, v20, v222
    v_fmac_f32 v39, v20, v223
    s_waitcnt lgkmcnt(1)
    v_fmac_f32 v36, v21, v252
    v_fmac_f32 v37, v21, v253
    v_fmac_f32 v38, v21, v254
    v_fmac_f32 v39, v21, v255
    s_waitcnt lgkmcnt(0)
    v_fmac_f32 v36, v22, v232
    v_fmac_f32 v37, v22, v233
    v_fmac_f32 v38, v22, v234
    v_fmac_f32 v39, v22, v235
    buffer_store_dwordx4 v[36:39], v8, s[40:43], s92 offen sc1
    s_mov_b32 s30, 1
    s_mov_b32 s31, 1
    s_mov_b64 exec, s[30:31]
    buffer_store_dwordx2 v[32:33], v2, s[40:43], s93 offen sc1
    s_mov_b64 exec, -1
    s_cmp_eq_u32 s89, 2
    s_cbranch_scc0 L_ts_nbt
    s_barrier
    s_branch L_wo_mm
L_ts_nbt:
    s_cmp_eq_u32 s89, 2
    s_cbranch_scc1 L_wo_mm
    s_cmp_eq_u32 s89, 1
    s_cbranch_scc1 L_fin
    s_barrier
    v_bfe_u32 v1, v0, 3, 1
    v_lshrrev_b32 v2, 4, v0
    v_lshl_add_u32 v1, v1, 2, v2
    v_mul_u32_u24 v8, 80, v1
    s_and_b32 s30, s81, 3
    s_mul_i32 s30, s30, 640
    s_add_u32 s30, s30, 16384
    v_add_u32 v8, s30, v8
    v_lshlrev_b32 v11, 2, v1
    v_lshrrev_b32 v12, 4, v0
    v_lshlrev_b32 v12, 3, v12
    v_and_b32 v9, 7, v0
    v_lshl_add_u32 v12, v9, 5, v12
    s_lshl_b32 s30, s81, 8
    s_add_u32 s30, s30, 24576
    v_add_u32 v9, s30, v12
    v_lshlrev_b32 v10, 2, v0
    v_add_u32 v10, 24576, v10
    v_and_b32 v14, 3, v0
    v_mov_b32 v6, 0xffff
    v_mov_b32 v7, 0xffff0000
    v_cmp_eq_u32 vcc, 0, v14
    s_nop 1
    v_cndmask_b32 v4, 0, v6, vcc
    v_cmp_eq_u32 vcc, 1, v14
    s_nop 1
    v_cndmask_b32 v4, v4, v7, vcc
    v_cmp_eq_u32 vcc, 2, v14
    s_nop 1
    v_cndmask_b32 v5, 0, v6, vcc
    v_cmp_eq_u32 vcc, 3, v14
    s_nop 1
    v_cndmask_b32 v5, v5, v7, vcc
    v_mov_b32 v60, 0
    v_mov_b32 v61, 0
    s_nop 1
    s_branch L_ffn_post
L_end:
    s_endpgm

.section .rodata,"a"
.p2align 6
.amdhsa_kernel adaLN_cond__gqa_block_cached__geglu_ffn__decode_kernel
  .amdhsa_next_free_vgpr 256
  .amdhsa_next_free_sgpr 102
  .amdhsa_accum_offset 256
  .amdhsa_group_segment_fixed_size 0
  .amdhsa_kernarg_size 112
  .amdhsa_user_sgpr_count 2
  .amdhsa_user_sgpr_kernarg_segment_ptr 1
  .amdhsa_system_sgpr_workgroup_id_x 1
.end_amdhsa_kernel
```
